```python
import torch

def _softmax(x, axis=-1):
    return torch.softmax(x, dim=axis)
def _gelu(x):
    return torch.nn.functional.gelu(x, approximate="tanh")
def _silu(x):
    return torch.nn.functional.silu(x)
def _sigmoid(x):
    return torch.sigmoid(x)
def _layernorm(x, axis=-1, eps=1e-5):
    m = x.mean(dim=axis, keepdim=True)
    v = x.var(dim=axis, keepdim=True, unbiased=False)
    return (x - m) / torch.sqrt(v + eps)
def _scatter_add(tgt, idx, src, axis=0):
    return tgt.clone().index_add_(axis, idx, src)
def _segment_sum(src, seg, n):
    out = torch.zeros((n,) + src.shape[1:], dtype=src.dtype)
    return out.index_add_(0, seg, src)
def _pad(x, pw):
    flat = tuple(v for pair in reversed(pw) for v in pair)
    return torch.nn.functional.pad(x, flat)

kernel_name = 'gated_mix__sliding_block__swiglu_ffn__prompt'

def setup_inputs():

    _w = (lambda a: (lambda t: t.to(torch.bfloat16) if t.is_floating_point() else t)(torch.as_tensor(a)))
    def _A_setup():
        B, S, D = 1, 2048, 640
        return {
            "x": _w((lambda *s: torch.randn(*s, dtype=torch.bfloat16) * 0.05)(B, S, D)),
            "wqkv": _w((lambda *s: torch.randn(*s, dtype=torch.bfloat16) * 0.8)(D, 3 * D)),
            "wo": _w((lambda *s: torch.randn(*s, dtype=torch.bfloat16) * 0.05)(D, D)),
        }
    _A_in = _A_setup()

    def _B_setup():
        B, S, D, F = 1, 2048, 640, 1536
        return {
            "x": _w((lambda *s: torch.randn(*s, dtype=torch.bfloat16) * 0.05)(B, S, D)),
            "w_gate": _w((lambda *s: torch.randn(*s, dtype=torch.bfloat16) * 0.2)(D, F)),
            "w_up": _w((lambda *s: torch.randn(*s, dtype=torch.bfloat16) * 0.2)(D, F)),
            "w_down": _w((lambda *s: torch.randn(*s, dtype=torch.bfloat16) * 0.2)(F, D)),
        }
    _B_in = _B_setup()

    return {
        "A_x": _A_in["x"],
        "A_wqkv": _A_in["wqkv"],
        "A_wo": _A_in["wo"],
        "B_x": _B_in["x"],
        "B_w_gate": _B_in["w_gate"],
        "B_w_up": _B_in["w_up"],
        "B_w_down": _B_in["w_down"],
        "gate_w": _w((lambda *s: torch.randn(*s, dtype=torch.bfloat16) * 0.05)(640) * 16.0),
    }

def reference(A_x, A_wqkv, A_wo, B_x, B_w_gate, B_w_up, B_w_down, gate_w):
    def _A_ref(x, wqkv, wo):
        B, S, D = x.shape
        H = 32; Dh = D // H; W = 256
        qkv = (lambda x, *d: x.permute(*d))((x @ wqkv).reshape(B, S, 3, H, Dh), 2, 0, 3, 1, 4)
        q, k, v = qkv[0], qkv[1], qkv[2]
        scores = torch.einsum("bhqd,bhkd->bhqk", q, k) * (Dh ** -0.5)
        idx = torch.arange(S)
        mask = (idx[:, None] - idx[None, :] >= 0) & (idx[:, None] - idx[None, :] < W)
        scores = torch.where(mask[None, None], scores, -1e9)
        p = _softmax(scores, axis=-1)
        o = torch.einsum("bhqk,bhkd->bhqd", p, v)
        return (lambda x, *d: x.permute(*d))(o, 0, 2, 1, 3).reshape(B, S, D) @ wo

    def _B_ref(x, w_gate, w_up, w_down):
        g = _silu(x @ w_gate)
        u = x @ w_up
        return (g * u) @ w_down

    x = A_x
    g = _sigmoid((x * gate_w).sum(-1, keepdims=True))
    a = _A_ref(x, A_wqkv, A_wo)
    b = _B_ref(x, B_w_gate, B_w_up, B_w_down)
    return g * a + (1 - g) * b
```

```asm
; @launch grid=(256,1,1) block=(512,1,1) lds=163840
.amdgcn_target "amdgcn-amd-amdhsa--gfx950"
.text
.globl gated_mix__sliding_block__swiglu_ffn__prompt_kernel
.p2align 8
.type gated_mix__sliding_block__swiglu_ffn__prompt_kernel,@function
gated_mix__sliding_block__swiglu_ffn__prompt_kernel:
  s_cmp_ge_u32 s2, 256
  s_cbranch_scc1 k_end
  s_load_dwordx16 s[4:19], s[0:1], 0
  s_load_dwordx4 s[20:23], s[0:1], 64
  s_load_dwordx2 s[24:25], s[0:1], 80
  s_getpc_b64 s[96:97]
k_cp0:
  s_lshr_b32 s98, s2, 3
  s_and_b32 s98, s98, 31
  s_lshl_b32 s98, s98, 10
  v_lshl_add_u32 v252, v0, 7, s98
  v_min_u32 v252, k_end-k_cp0, v252
  v_mov_b32 v253, s97
  v_add_co_u32 v252, vcc, s96, v252
  v_cmp_gt_u32 s[98:99], 8, v0
  s_nop 0
  v_addc_co_u32 v253, vcc, 0, v253, vcc
  s_and_b64 exec, exec, s[98:99]
  s_cbranch_execz k_cp1
  global_load_dword v247, v[252:253], off
k_cp1:
  s_mov_b64 exec, -1
  v_lshrrev_b32 v1, 6, v0
  v_and_b32 v0, 63, v0
  v_readfirstlane_b32 s26, v1
  s_and_b32 s73, s2, 7
  s_lshr_b32 s74, s2, 3
  s_and_b32 s70, s73, 1
  s_lshl_b32 s70, s70, 3
  s_and_b32 s75, s74, 7
  s_add_u32 s70, s70, s75
  s_lshr_b32 s71, s73, 1
  s_lshr_b32 s74, s74, 3
  s_add_u32 s92, s74, s75
  s_and_b32 s92, s92, 1
  s_mov_b32 s90, 0
  s_mov_b32 s91, 0
  s_lshl_b32 s74, s74, 2
  s_add_u32 s71, s71, s74
  s_mul_i32 s73, s71, 5
  s_sub_u32 s73, s73, 50
  s_add_u32 s72, s71, 6
  s_lshr_b32 s72, s72, 3
  s_sub_u32 s72, s71, s72
  s_cmp_lt_u32 s71, 12
  s_cselect_b32 s72, s72, s73
  s_mov_b32 s62, 3840
  s_cselect_b32 s63, 3072, s62
  s_and_b32 s73, s26, 3
  s_lshr_b32 s27, s26, 2
  v_lshrrev_b32 v168, 3, v0
  v_and_b32 v169, 7, v0
  v_bfe_u32 v170, v0, 4, 1
  s_and_b32 s76, s26, 1
  s_lshl_b32 s75, s76, 1
  v_or_b32 v170, s75, v170
  v_lshlrev_b32 v170, 1, v170
  v_xor_b32 v170, v170, v169
  v_lshlrev_b32 v170, 4, v170
  s_lshl_b32 s75, s73, 3
  v_add_u32 v171, s75, v168
  v_mad_u32_u24 v1, v171, s62, v170
  v_mad_u32_u24 v2, v171, s63, v170
  s_lshr_b32 s75, s26, 1
  s_lshl_b32 s75, s75, 5
  s_add_u32 s75, s75, s76
  v_lshl_add_u32 v171, v168, 1, s75
  v_mul_u32_u24 v171, 1280, v171
  v_lshrrev_b32 v172, 4, v0
  v_xor_b32 v172, v172, v169
  v_lshl_add_u32 v3, v172, 4, v171
  v_xor_b32 v4, 64, v3
  v_add_u32 v4, 20480, v4
  s_xor_b32 s75, s27, 1
  s_mul_i32 s64, s75, 20480
  s_lshl_b32 s76, s73, 10
  s_add_u32 s64, s64, s76
  s_lshl_b32 s75, s75, 5
  s_mul_i32 s88, s75, s62
  s_mul_i32 s89, s75, s63
  s_lshl_b32 s62, s62, 6
  s_lshl_b32 s63, s63, 6
  s_mul_i32 s60, s92, s62
  s_mul_i32 s61, s92, s63
  s_add_u32 s60, s60, s88
  s_add_u32 s61, s61, s89
  s_lshl_b32 s65, s92, 7
  s_lshl_b32 s66, s26, 11
  s_add_u32 s66, s66, 102400
  s_mul_i32 s75, s70, 163840
  s_lshl_b32 s76, s72, 7
  s_waitcnt lgkmcnt(0)
  s_add_u32 s28, s4, s75
  s_addc_u32 s29, s5, 0
  s_mov_b32 s30, 163840
  s_mov_b32 s31, 0x20000
  s_add_u32 s32, s6, s76
  s_addc_u32 s33, s7, 0
  s_mov_b32 s34, 2453888
  s_mov_b32 s35, 0x20000
  s_cmp_lt_u32 s71, 12
  s_cbranch_scc1 k_s1g
  s_add_u32 s36, s32, 128
  s_addc_u32 s37, s33, 0
  s_mov_b32 s38, 2453888
  s_mov_b32 s39, 0x20000
  s_add_u32 s40, s32, 256
  s_addc_u32 s41, s33, 0
  s_mov_b32 s42, 2453888
  s_mov_b32 s43, 0x20000
  s_add_u32 s44, s32, 384
  s_addc_u32 s45, s33, 0
  s_mov_b32 s46, 2453888
  s_mov_b32 s47, 0x20000
  s_add_u32 s48, s32, 512
  s_addc_u32 s49, s33, 0
  s_mov_b32 s50, 2453888
  s_mov_b32 s51, 0x20000
  s_branch k_s1h
k_s1g:
  s_lshl_b32 s76, s71, 8
  s_add_u32 s36, s12, s76
  s_addc_u32 s37, s13, 0
  s_mov_b32 s38, 1963136
  s_mov_b32 s39, 0x20000
  s_add_u32 s40, s36, 128
  s_addc_u32 s41, s37, 0
  s_mov_b32 s42, 1963136
  s_mov_b32 s43, 0x20000
  s_add_u32 s44, s14, s76
  s_addc_u32 s45, s15, 0
  s_mov_b32 s46, 1963136
  s_mov_b32 s47, 0x20000
  s_add_u32 s48, s44, 128
  s_addc_u32 s49, s45, 0
  s_mov_b32 s50, 1963136
  s_mov_b32 s51, 0x20000
  s_and_b32 s76, s71, 7
  s_cmp_eq_u32 s76, 1
  s_cselect_b32 s34, 0, s34
k_s1h:
  s_cmp_eq_u32 s27, 0
  s_cbranch_scc1 k_pa0
  s_add_u32 m0, s64, 0
  s_nop 0
  buffer_load_dwordx4 v1, s[32:35], s60 offen lds
  s_add_u32 m0, s64, 4096
  s_nop 0
  buffer_load_dwordx4 v2, s[36:39], s61 offen lds
  s_add_u32 m0, s64, 8192
  s_nop 0
  buffer_load_dwordx4 v2, s[40:43], s61 offen lds
  s_add_u32 m0, s64, 12288
  s_nop 0
  buffer_load_dwordx4 v2, s[44:47], s61 offen lds
  s_add_u32 m0, s64, 16384
  s_nop 0
  buffer_load_dwordx4 v2, s[48:51], s61 offen lds
  s_add_u32 s90, s90, 1
  s_xor_b32 s73, s90, s92
  s_mul_i32 s60, s73, s62
  s_mul_i32 s61, s73, s63
  s_add_u32 s60, s60, s88
  s_add_u32 s61, s61, s89
  s_add_u32 s64, s64, 40960
  s_cmp_ge_u32 s64, 102400
  s_cselect_b32 s73, 102400, 0
  s_sub_u32 s64, s64, s73
  s_add_u32 m0, s66, 0
  s_nop 0
  buffer_load_dwordx4 v3, s[28:31], s65 offen lds
  s_add_u32 m0, s66, 1024
  s_nop 0
  buffer_load_dwordx4 v4, s[28:31], s65 offen lds
  s_add_u32 s91, s91, 1
  s_xor_b32 s73, s91, s92
  s_lshl_b32 s65, s73, 7
  s_add_u32 s66, s66, 16384
  s_cmp_ge_u32 s66, 151552
  s_cselect_b32 s73, 49152, 0
  s_sub_u32 s66, s66, s73
  s_branch k_pae
k_pa0:
  s_add_u32 m0, s66, 0
  s_nop 0
  buffer_load_dwordx4 v3, s[28:31], s65 offen lds
  s_add_u32 m0, s66, 1024
  s_nop 0
  buffer_load_dwordx4 v4, s[28:31], s65 offen lds
  s_add_u32 s91, s91, 1
  s_xor_b32 s73, s91, s92
  s_lshl_b32 s65, s73, 7
  s_add_u32 s66, s66, 16384
  s_cmp_ge_u32 s66, 151552
  s_cselect_b32 s73, 49152, 0
  s_sub_u32 s66, s66, s73
  s_add_u32 m0, s64, 0
  s_nop 0
  buffer_load_dwordx4 v1, s[32:35], s60 offen lds
  s_add_u32 m0, s64, 4096
  s_nop 0
  buffer_load_dwordx4 v2, s[36:39], s61 offen lds
  s_add_u32 m0, s64, 8192
  s_nop 0
  buffer_load_dwordx4 v2, s[40:43], s61 offen lds
  s_add_u32 m0, s64, 12288
  s_nop 0
  buffer_load_dwordx4 v2, s[44:47], s61 offen lds
  s_add_u32 m0, s64, 16384
  s_nop 0
  buffer_load_dwordx4 v2, s[48:51], s61 offen lds
  s_add_u32 s90, s90, 1
  s_xor_b32 s73, s90, s92
  s_mul_i32 s60, s73, s62
  s_mul_i32 s61, s73, s63
  s_add_u32 s60, s60, s88
  s_add_u32 s61, s61, s89
  s_add_u32 s64, s64, 40960
  s_cmp_ge_u32 s64, 102400
  s_cselect_b32 s73, 102400, 0
  s_sub_u32 s64, s64, s73
k_pae:
  s_mov_b32 s52, s24
  s_mov_b32 s53, s25
  s_mov_b32 s54, 27262976
  s_mov_b32 s55, 0x20000
  s_mov_b32 s56, s18
  s_mov_b32 s57, s19
  s_mov_b32 s58, 1280
  s_mov_b32 s59, 0x20000
  v_lshlrev_b32 v244, 4, v0
  v_lshlrev_b32 v248, 2, v0
  s_lshl_b32 s75, s71, 3
  s_add_u32 s75, s75, s26
  s_mul_i32 s76, s75, 1280
  buffer_load_dwordx4 v[184:187], v244, s[28:31], s76 offen
  buffer_load_dword v188, v248, s[28:31], s76 offen offset:1024
  buffer_load_dwordx4 v[190:193], v244, s[56:59], 0 offen
  buffer_load_dword v194, v248, s[56:59], 0 offen offset:1024
  s_cmp_eq_u32 s2, 0
  s_cbranch_scc0 k_noclr
  s_mul_i32 s78, s26, 6144
  s_add_u32 s78, s78, 22085632
  v_mov_b32 v16, 0
  v_mov_b32 v17, 0
  v_mov_b32 v18, 0
  v_mov_b32 v19, 0
  buffer_store_dwordx4 v[16:19], v244, s[52:55], s78 offen offset:0 sc1
  buffer_store_dwordx4 v[16:19], v244, s[52:55], s78 offen offset:1024 sc1
  buffer_store_dwordx4 v[16:19], v244, s[52:55], s78 offen offset:2048 sc1
  buffer_store_dwordx4 v[16:19], v244, s[52:55], s78 offen offset:3072 sc1
  s_add_u32 s78, s78, 4096
  buffer_store_dwordx4 v[16:19], v244, s[52:55], s78 offen offset:0 sc1
  buffer_store_dwordx4 v[16:19], v244, s[52:55], s78 offen offset:1024 sc1
k_noclr:
  v_mov_b32 v246, 1
  v_mov_b32 v208, 0
  v_mov_b32 v209, 0
  s_cmp_eq_u32 s27, 0
  s_cbranch_scc1 k_pc0
  s_add_u32 m0, s64, 0
  s_nop 0
  buffer_load_dwordx4 v1, s[32:35], s60 offen lds
  s_add_u32 m0, s64, 4096
  s_nop 0
  buffer_load_dwordx4 v2, s[36:39], s61 offen lds
  s_add_u32 m0, s64, 8192
  s_nop 0
  buffer_load_dwordx4 v2, s[40:43], s61 offen lds
  s_add_u32 m0, s64, 12288
  s_nop 0
  buffer_load_dwordx4 v2, s[44:47], s61 offen lds
  s_add_u32 m0, s64, 16384
  s_nop 0
  buffer_load_dwordx4 v2, s[48:51], s61 offen lds
  s_add_u32 s90, s90, 1
  s_xor_b32 s73, s90, s92
  s_mul_i32 s60, s73, s62
  s_mul_i32 s61, s73, s63
  s_add_u32 s60, s60, s88
  s_add_u32 s61, s61, s89
  s_add_u32 s64, s64, 40960
  s_cmp_ge_u32 s64, 102400
  s_cselect_b32 s73, 102400, 0
  s_sub_u32 s64, s64, s73
  s_branch k_pce
k_pc0:
  s_add_u32 m0, s66, 0
  s_nop 0
  buffer_load_dwordx4 v3, s[28:31], s65 offen lds
  s_add_u32 m0, s66, 1024
  s_nop 0
  buffer_load_dwordx4 v4, s[28:31], s65 offen lds
  s_add_u32 s91, s91, 1
  s_xor_b32 s73, s91, s92
  s_lshl_b32 s65, s73, 7
  s_add_u32 s66, s66, 16384
  s_cmp_ge_u32 s66, 151552
  s_cselect_b32 s73, 49152, 0
  s_sub_u32 s66, s66, s73
k_pce:
  s_mov_b32 s56, s22
  s_mov_b32 s57, s23
  s_mov_b32 s58, 256
  s_mov_b32 s59, 0x20000
  v_lshrrev_b32 v180, 4, v0
  v_bfe_u32 v181, v0, 2, 2
  v_and_b32 v182, 3, v0
  v_lshlrev_b32 v5, 10, v180
  v_lshl_add_u32 v5, v181, 7, v5
  v_lshl_add_u32 v5, v182, 3, v5
  v_bfe_u32 v182, v0, 3, 2
  s_and_b32 s73, s26, 3
  v_xor_b32 v182, s73, v182
  v_lshl_add_u32 v5, v182, 5, v5
  v_and_b32 v181, 15, v0
  v_bfe_u32 v182, v0, 1, 3
  v_xor_b32 v182, v182, v180
  v_lshlrev_b32 v182, 4, v182
  v_lshl_add_u32 v182, v181, 7, v182
  s_lshl_b32 s73, s27, 13
  v_add_u32 v6, s73, v182
  v_xor_b32 v7, 64, v6
  s_mov_b32 s67, 0
  s_mov_b32 s68, 102400
  v_mov_b32 v8, v5
  v_add_u32 v9, s68, v6
  s_mov_b32 s69, 0
  s_cmp_eq_u32 s27, 0
  s_cbranch_scc1 k_l0pre
  s_waitcnt vmcnt(9)
  s_barrier
  ds_read_b128 v[116:119], v9 offset:0
  ds_read_b64_tr_b16 v[96:97], v8 offset:0
  ds_read_b64_tr_b16 v[98:99], v8 offset:512
  ds_read_b128 v[120:123], v9 offset:2048
  ds_read_b128 v[124:127], v9 offset:4096
  ds_read_b128 v[128:131], v9 offset:6144
  ds_read_b64_tr_b16 v[100:101], v8 offset:4096
  ds_read_b64_tr_b16 v[102:103], v8 offset:4608
  ds_read_b64_tr_b16 v[104:105], v8 offset:8192
  ds_read_b64_tr_b16 v[106:107], v8 offset:8704
  ds_read_b64_tr_b16 v[108:109], v8 offset:12288
  ds_read_b64_tr_b16 v[110:111], v8 offset:12800
  ds_read_b64_tr_b16 v[112:113], v8 offset:16384
  ds_read_b64_tr_b16 v[114:115], v8 offset:16896
  s_add_u32 s67, s67, 20480
  s_cmp_ge_u32 s67, 102400
  s_cselect_b32 s67, 0, s67
  v_add_u32 v8, s67, v5
  v_add_u32 v9, s68, v7
  s_waitcnt lgkmcnt(0)
  s_barrier
  v_mfma_f32_16x16x32_bf16 v[16:19], v[96:99], v[116:119], 0
  s_add_u32 m0, s66, 0
  s_add_u32 s67, s67, 20480
  s_lshl_b32 s78, s70, 4
  s_add_u32 s78, s78, s71
  s_lshl_b32 s79, s78, 5
  v_mfma_f32_16x16x32_bf16 v[20:23], v[96:99], v[120:123], 0
  buffer_load_dwordx4 v3, s[28:31], s65 offen lds
  ds_read_b128 v[152:155], v9 offset:0
  s_lshl_b32 s78, s78, 7
  s_add_u32 s79, s79, 22118400
  v_mfma_f32_16x16x32_bf16 v[24:27], v[96:99], v[124:127], 0
  ds_read_b64_tr_b16 v[132:133], v8 offset:0
  s_add_u32 m0, s66, 1024
  v_mov_b32 v245, s79
  s_add_u32 s78, s78, 22085632
  v_writelane_b32 v245, s78, 2
  v_mfma_f32_16x16x32_bf16 v[28:31], v[96:99], v[128:131], 0
  buffer_load_dwordx4 v4, s[28:31], s65 offen lds
  ds_read_b64_tr_b16 v[134:135], v8 offset:512
  s_cmp_ge_u32 s67, 102400
  s_cselect_b32 s67, 0, s67
  s_lshr_b32 s78, s2, 3
  s_lshl_b32 s78, s78, 5
  v_mfma_f32_16x16x32_bf16 v[32:35], v[100:103], v[116:119], 0
  ds_read_b128 v[156:159], v9 offset:2048
  s_and_b32 s79, s2, 7
  s_add_u32 s78, s78, s79
  v_mfma_f32_16x16x32_bf16 v[36:39], v[100:103], v[120:123], 0
  ds_read_b128 v[160:163], v9 offset:4096
  s_add_u32 s91, s91, 1
  s_xor_b32 s73, s91, s92
  s_lshl_b32 s65, s73, 7
  s_add_u32 s66, s66, 16384
  s_cmp_ge_u32 s66, 151552
  s_cselect_b32 s73, 49152, 0
  s_sub_u32 s66, s66, s73
  s_lshl_b32 s78, s78, 2
  s_add_u32 s78, s78, 22126592
  v_writelane_b32 v245, s78, 1
  v_mfma_f32_16x16x32_bf16 v[40:43], v[100:103], v[124:127], 0
  ds_read_b128 v[164:167], v9 offset:6144
  s_add_u32 m0, s64, 0
  s_add_u32 s78, s78, 4096
  v_writelane_b32 v245, s78, 3
  v_mfma_f32_16x16x32_bf16 v[44:47], v[100:103], v[128:131], 0
  buffer_load_dwordx4 v1, s[32:35], s60 offen lds
  ds_read_b64_tr_b16 v[136:137], v8 offset:4096
  s_add_u32 s68, s68, 16384
  s_mul_i32 s77, s2, 3
  s_sub_u32 s83, s26, 4
  s_add_u32 s77, s77, s83
  v_mfma_f32_16x16x32_bf16 v[48:51], v[104:107], v[116:119], 0
  ds_read_b64_tr_b16 v[138:139], v8 offset:4608
  s_add_u32 m0, s64, 4096
  s_cmp_lt_u32 s83, 3
  s_cselect_b32 s77, s77, 1000
  s_mul_i32 s78, s77, 6554
  v_mfma_f32_16x16x32_bf16 v[52:55], v[104:107], v[120:123], 0
  buffer_load_dwordx4 v2, s[36:39], s61 offen lds
  ds_read_b64_tr_b16 v[140:141], v8 offset:8192
  s_lshr_b32 s78, s78, 16
  s_mul_i32 s79, s78, 10
  v_mfma_f32_16x16x32_bf16 v[56:59], v[104:107], v[124:127], 0
  ds_read_b64_tr_b16 v[142:143], v8 offset:8704
  s_add_u32 m0, s64, 8192
  s_cmp_ge_u32 s68, 151552
  s_cselect_b32 s68, 102400, s68
  s_sub_u32 s79, s77, s79
  s_lshl_b32 s79, s79, 7
  s_lshr_b32 s80, s78, 2
  v_mfma_f32_16x16x32_bf16 v[60:63], v[104:107], v[128:131], 0
  buffer_load_dwordx4 v2, s[40:43], s61 offen lds
  ds_read_b64_tr_b16 v[144:145], v8 offset:12288
  s_lshl_b32 s80, s80, 7
  s_and_b32 s81, s78, 3
  v_mfma_f32_16x16x32_bf16 v[64:67], v[108:111], v[116:119], 0
  ds_read_b64_tr_b16 v[146:147], v8 offset:12800
  s_add_u32 m0, s64, 12288
  s_lshl_b32 s81, s81, 4
  s_add_u32 s80, s80, s81
  s_sub_u32 s81, s78, 48
  v_mfma_f32_16x16x32_bf16 v[68:71], v[108:111], v[120:123], 0
  buffer_load_dwordx4 v2, s[44:47], s61 offen lds
  ds_read_b64_tr_b16 v[148:149], v8 offset:16384
  s_lshl_b32 s81, s81, 5
  s_cmp_lt_u32 s78, 48
  s_cselect_b32 s80, s80, s81
  s_mov_b32 s81, 20480
  s_mov_b32 s86, 819200
  s_cselect_b32 s81, 81920, s81
  s_cselect_b32 s84, s16, s8
  s_cselect_b32 s85, s17, s9
  s_cselect_b32 s86, 1966080, s86
  v_mfma_f32_16x16x32_bf16 v[72:75], v[108:111], v[124:127], 0
  ds_read_b64_tr_b16 v[150:151], v8 offset:16896
  s_mov_b32 s87, 0x20000
  s_mul_i32 s80, s80, 1280
  v_mfma_f32_16x16x32_bf16 v[76:79], v[108:111], v[128:131], 0
  v_add_u32 v8, s67, v5
  s_add_u32 m0, s64, 16384
  s_add_u32 s80, s80, s79
  v_mul_u32_u24 v178, 1280, v168
  v_lshl_add_u32 v178, v169, 4, v178
  v_mfma_f32_16x16x32_bf16 v[80:83], v[112:115], v[116:119], 0
  buffer_load_dwordx4 v2, s[48:51], s61 offen lds
  v_add_u32 v9, s68, v6
  s_lshl_b32 s79, s83, 12
  s_add_u32 s79, s79, 151552
  v_mfma_f32_16x16x32_bf16 v[84:87], v[112:115], v[120:123], 0
  s_add_u32 s90, s90, 1
  s_xor_b32 s73, s90, s92
  s_mul_i32 s60, s73, s62
  s_mul_i32 s61, s73, s63
  s_add_u32 s60, s60, s88
  s_add_u32 s61, s61, s89
  s_add_u32 s64, s64, 40960
  s_cmp_ge_u32 s64, 102400
  s_cselect_b32 s73, 102400, 0
  s_sub_u32 s64, s64, s73
  v_lshrrev_b32 v177, 2, v0
  v_lshlrev_b32 v177, 7, v177
  v_and_b32 v176, 3, v0
  v_mfma_f32_16x16x32_bf16 v[88:91], v[112:115], v[124:127], 0
  v_lshl_add_u32 v177, v176, 3, v177
  v_add_u32 v177, s79, v177
  v_mfma_f32_16x16x32_bf16 v[92:95], v[112:115], v[128:131], 0
  s_lshl_b32 s95, s77, 12
  s_add_u32 s95, s95, 18874368
  s_waitcnt lgkmcnt(0) vmcnt(5)
  s_barrier
  v_mfma_f32_16x16x32_bf16 v[16:19], v[132:135], v[152:155], v[16:19]
  s_add_u32 m0, s66, 0
  s_add_u32 s67, s67, 20480
  v_mov_b32 v179, 0
  v_lshlrev_b32 v180, 16, v184
  v_lshlrev_b32 v181, 16, v190
  v_fmac_f32 v179, v180, v181
  v_mfma_f32_16x16x32_bf16 v[20:23], v[132:135], v[156:159], v[20:23]
  buffer_load_dwordx4 v3, s[28:31], s65 offen lds
  ds_read_b128 v[116:119], v9 offset:0
  v_and_b32 v182, 0xffff0000, v184
  v_and_b32 v183, 0xffff0000, v190
  v_fmac_f32 v179, v182, v183
  v_mfma_f32_16x16x32_bf16 v[24:27], v[132:135], v[160:163], v[24:27]
  ds_read_b64_tr_b16 v[96:97], v8 offset:0
  s_add_u32 m0, s66, 1024
  v_lshlrev_b32 v180, 16, v185
  v_lshlrev_b32 v181, 16, v191
  v_fmac_f32 v179, v180, v181
  v_mfma_f32_16x16x32_bf16 v[28:31], v[132:135], v[164:167], v[28:31]
  buffer_load_dwordx4 v4, s[28:31], s65 offen lds
  ds_read_b64_tr_b16 v[98:99], v8 offset:512
  v_and_b32 v182, 0xffff0000, v185
  v_and_b32 v183, 0xffff0000, v191
  v_fmac_f32 v179, v182, v183
  v_mfma_f32_16x16x32_bf16 v[32:35], v[136:139], v[152:155], v[32:35]
  ds_read_b128 v[120:123], v9 offset:2048
  v_lshlrev_b32 v180, 16, v186
  v_lshlrev_b32 v181, 16, v192
  v_fmac_f32 v179, v180, v181
  v_mfma_f32_16x16x32_bf16 v[36:39], v[136:139], v[156:159], v[36:39]
  ds_read_b128 v[124:127], v9 offset:4096
  s_add_u32 s91, s91, 1
  s_xor_b32 s73, s91, s92
  s_lshl_b32 s65, s73, 7
  s_add_u32 s66, s66, 16384
  s_cmp_ge_u32 s66, 151552
  s_cselect_b32 s73, 49152, 0
  s_sub_u32 s66, s66, s73
  v_and_b32 v182, 0xffff0000, v186
  v_and_b32 v183, 0xffff0000, v192
  v_fmac_f32 v179, v182, v183
  v_mfma_f32_16x16x32_bf16 v[40:43], v[136:139], v[160:163], v[40:43]
  ds_read_b128 v[128:131], v9 offset:6144
  s_add_u32 m0, s64, 0
  v_lshlrev_b32 v180, 16, v187
  v_lshlrev_b32 v181, 16, v193
  v_fmac_f32 v179, v180, v181
  v_mfma_f32_16x16x32_bf16 v[44:47], v[136:139], v[164:167], v[44:47]
  buffer_load_dwordx4 v1, s[32:35], s60 offen lds
  ds_read_b64_tr_b16 v[100:101], v8 offset:4096
  s_cmp_ge_u32 s67, 102400
  s_cselect_b32 s67, 0, s67
  v_and_b32 v182, 0xffff0000, v187
  v_and_b32 v183, 0xffff0000, v193
  v_fmac_f32 v179, v182, v183
  v_mfma_f32_16x16x32_bf16 v[48:51], v[140:143], v[152:155], v[48:51]
  ds_read_b64_tr_b16 v[102:103], v8 offset:4608
  v_lshlrev_b32 v180, 16, v188
  v_lshlrev_b32 v181, 16, v194
  v_fmac_f32 v179, v180, v181
  v_mfma_f32_16x16x32_bf16 v[52:55], v[140:143], v[156:159], v[52:55]
  ds_read_b64_tr_b16 v[104:105], v8 offset:8192
  s_add_u32 m0, s64, 4096
  v_and_b32 v182, 0xffff0000, v188
  v_and_b32 v183, 0xffff0000, v194
  v_fmac_f32 v179, v182, v183
  v_mfma_f32_16x16x32_bf16 v[56:59], v[140:143], v[160:163], v[56:59]
  buffer_load_dwordx4 v2, s[36:39], s61 offen lds
  ds_read_b64_tr_b16 v[106:107], v8 offset:8704
  s_nop 0
  v_add_f32_dpp v179, v179, v179 row_shr:1 bound_ctrl:0
  v_mfma_f32_16x16x32_bf16 v[60:63], v[140:143], v[164:167], v[60:63]
  ds_read_b64_tr_b16 v[108:109], v8 offset:12288
  s_add_u32 m0, s64, 8192
  s_nop 0
  v_add_f32_dpp v179, v179, v179 row_shr:2 bound_ctrl:0
  v_mfma_f32_16x16x32_bf16 v[64:67], v[144:147], v[152:155], v[64:67]
  buffer_load_dwordx4 v2, s[40:43], s61 offen lds
  ds_read_b64_tr_b16 v[110:111], v8 offset:12800
  s_nop 0
  v_add_f32_dpp v179, v179, v179 row_shr:4 bound_ctrl:0
  v_mfma_f32_16x16x32_bf16 v[68:71], v[144:147], v[156:159], v[68:71]
  ds_read_b64_tr_b16 v[112:113], v8 offset:16384
  s_nop 0
  v_add_f32_dpp v179, v179, v179 row_shr:8 bound_ctrl:0
  v_mfma_f32_16x16x32_bf16 v[72:75], v[144:147], v[160:163], v[72:75]
  ds_read_b64_tr_b16 v[114:115], v8 offset:16896
  s_add_u32 m0, s64, 12288
  s_nop 0
  v_add_f32_dpp v179, v179, v179 row_bcast:15 row_mask:0xa
  v_mfma_f32_16x16x32_bf16 v[76:79], v[144:147], v[164:167], v[76:79]
  buffer_load_dwordx4 v2, s[44:47], s61 offen lds
  v_add_u32 v8, s67, v5
  s_nop 0
  v_add_f32_dpp v179, v179, v179 row_bcast:31 row_mask:0xc
  v_mfma_f32_16x16x32_bf16 v[80:83], v[148:151], v[152:155], v[80:83]
  v_add_u32 v9, s68, v7
  s_add_u32 m0, s64, 16384
  v_mul_f32 v179, 0xbfb8aa3b, v179
  v_exp_f32 v179, v179
  s_lshl_b32 s78, s70, 4
  s_add_u32 s78, s78, s71
  v_mfma_f32_16x16x32_bf16 v[84:87], v[148:151], v[156:159], v[84:87]
  buffer_load_dwordx4 v2, s[48:51], s61 offen lds
  v_add_f32 v179, 1.0, v179
  v_rcp_f32 v179, v179
  s_lshl_b32 s78, s78, 5
  s_add_u32 s78, s78, s26
  v_mfma_f32_16x16x32_bf16 v[88:91], v[148:151], v[160:163], v[88:91]
  s_lshl_b32 s78, s78, 2
  s_add_u32 s78, s78, 22019844
  v_mfma_f32_16x16x32_bf16 v[92:95], v[148:151], v[164:167], v[92:95]
  s_mov_b32 exec_lo, 0
  s_brev_b32 exec_hi, 1
  buffer_store_dword v179, v248, s[52:55], s78 offen sc1
  s_mov_b64 exec, -1
  s_mov_b32 s69, 1
  s_branch k_side
k_l1:
  s_waitcnt lgkmcnt(0)
  s_barrier
  v_mfma_f32_16x16x32_bf16 v[16:19], v[96:99], v[116:119], v[16:19]
  s_add_u32 s67, s67, 20480
  v_mfma_f32_16x16x32_bf16 v[20:23], v[96:99], v[120:123], v[20:23]
  ds_read_b128 v[152:155], v9 offset:0
  s_cmp_ge_u32 s67, 102400
  s_cselect_b32 s67, 0, s67
  v_mfma_f32_16x16x32_bf16 v[24:27], v[96:99], v[124:127], v[24:27]
  ds_read_b64_tr_b16 v[132:133], v8 offset:0
  s_add_u32 s68, s68, 16384
  v_mfma_f32_16x16x32_bf16 v[28:31], v[96:99], v[128:131], v[28:31]
  ds_read_b64_tr_b16 v[134:135], v8 offset:512
  s_cmp_ge_u32 s68, 151552
  s_cselect_b32 s68, 102400, s68
  v_mfma_f32_16x16x32_bf16 v[32:35], v[100:103], v[116:119], v[32:35]
  ds_read_b128 v[156:159], v9 offset:2048
  s_add_u32 s90, s90, 1
  v_mfma_f32_16x16x32_bf16 v[36:39], v[100:103], v[120:123], v[36:39]
  ds_read_b128 v[160:163], v9 offset:4096
  s_xor_b32 s73, s90, s92
  v_mfma_f32_16x16x32_bf16 v[40:43], v[100:103], v[124:127], v[40:43]
  ds_read_b128 v[164:167], v9 offset:6144
  s_add_u32 m0, s66, 0
  s_mul_i32 s60, s73, s62
  v_mfma_f32_16x16x32_bf16 v[44:47], v[100:103], v[128:131], v[44:47]
  buffer_load_dwordx4 v3, s[28:31], s65 offen lds
  ds_read_b64_tr_b16 v[136:137], v8 offset:4096
  s_mul_i32 s61, s73, s63
  v_mfma_f32_16x16x32_bf16 v[48:51], v[104:107], v[116:119], v[48:51]
  ds_read_b64_tr_b16 v[138:139], v8 offset:4608
  s_add_u32 s60, s60, s88
  v_mfma_f32_16x16x32_bf16 v[52:55], v[104:107], v[120:123], v[52:55]
  ds_read_b64_tr_b16 v[140:141], v8 offset:8192
  s_add_u32 s61, s61, s89
  v_mfma_f32_16x16x32_bf16 v[56:59], v[104:107], v[124:127], v[56:59]
  ds_read_b64_tr_b16 v[142:143], v8 offset:8704
  s_add_u32 s64, s64, 40960
  v_mfma_f32_16x16x32_bf16 v[60:63], v[104:107], v[128:131], v[60:63]
  ds_read_b64_tr_b16 v[144:145], v8 offset:12288
  s_cmp_ge_u32 s64, 102400
  s_cselect_b32 s73, 102400, 0
  v_mfma_f32_16x16x32_bf16 v[64:67], v[108:111], v[116:119], v[64:67]
  ds_read_b64_tr_b16 v[146:147], v8 offset:12800
  s_sub_u32 s64, s64, s73
  v_mfma_f32_16x16x32_bf16 v[68:71], v[108:111], v[120:123], v[68:71]
  ds_read_b64_tr_b16 v[148:149], v8 offset:16384
  s_add_u32 m0, s66, 1024
  v_mfma_f32_16x16x32_bf16 v[72:75], v[108:111], v[124:127], v[72:75]
  buffer_load_dwordx4 v4, s[28:31], s65 offen lds
  ds_read_b64_tr_b16 v[150:151], v8 offset:16896
  v_mfma_f32_16x16x32_bf16 v[76:79], v[108:111], v[128:131], v[76:79]
  v_add_u32 v8, s67, v5
  v_mfma_f32_16x16x32_bf16 v[80:83], v[112:115], v[116:119], v[80:83]
  v_add_u32 v9, s68, v6
  v_mfma_f32_16x16x32_bf16 v[84:87], v[112:115], v[120:123], v[84:87]
  v_mfma_f32_16x16x32_bf16 v[88:91], v[112:115], v[124:127], v[88:91]
  v_mfma_f32_16x16x32_bf16 v[92:95], v[112:115], v[128:131], v[92:95]
  s_cmp_eq_u32 s69, 7
  s_cbranch_scc1 k_tail
  s_waitcnt lgkmcnt(0) vmcnt(7)
  s_barrier
  v_mfma_f32_16x16x32_bf16 v[16:19], v[132:135], v[152:155], v[16:19]
  s_add_u32 s67, s67, 20480
  v_mfma_f32_16x16x32_bf16 v[20:23], v[132:135], v[156:159], v[20:23]
  ds_read_b128 v[116:119], v9 offset:0
  s_add_u32 m0, s64, 0
  s_cmp_ge_u32 s67, 102400
  s_cselect_b32 s67, 0, s67
  v_mfma_f32_16x16x32_bf16 v[24:27], v[132:135], v[160:163], v[24:27]
  buffer_load_dwordx4 v1, s[32:35], s60 offen lds
  ds_read_b64_tr_b16 v[96:97], v8 offset:0
  v_mfma_f32_16x16x32_bf16 v[28:31], v[132:135], v[164:167], v[28:31]
  ds_read_b64_tr_b16 v[98:99], v8 offset:512
  s_add_u32 s91, s91, 1
  v_mfma_f32_16x16x32_bf16 v[32:35], v[136:139], v[152:155], v[32:35]
  ds_read_b128 v[120:123], v9 offset:2048
  s_add_u32 m0, s64, 4096
  v_mfma_f32_16x16x32_bf16 v[36:39], v[136:139], v[156:159], v[36:39]
  buffer_load_dwordx4 v2, s[36:39], s61 offen lds
  ds_read_b128 v[124:127], v9 offset:4096
  s_xor_b32 s73, s91, s92
  v_mfma_f32_16x16x32_bf16 v[40:43], v[136:139], v[160:163], v[40:43]
  ds_read_b128 v[128:131], v9 offset:6144
  v_mfma_f32_16x16x32_bf16 v[44:47], v[136:139], v[164:167], v[44:47]
  ds_read_b64_tr_b16 v[100:101], v8 offset:4096
  s_lshl_b32 s65, s73, 7
  v_mfma_f32_16x16x32_bf16 v[48:51], v[140:143], v[152:155], v[48:51]
  ds_read_b64_tr_b16 v[102:103], v8 offset:4608
  s_add_u32 m0, s64, 8192
  s_add_u32 s66, s66, 16384
  v_mfma_f32_16x16x32_bf16 v[52:55], v[140:143], v[156:159], v[52:55]
  buffer_load_dwordx4 v2, s[40:43], s61 offen lds
  ds_read_b64_tr_b16 v[104:105], v8 offset:8192
  v_mfma_f32_16x16x32_bf16 v[56:59], v[140:143], v[160:163], v[56:59]
  ds_read_b64_tr_b16 v[106:107], v8 offset:8704
  s_cmp_ge_u32 s66, 151552
  s_cselect_b32 s73, 49152, 0
  v_mfma_f32_16x16x32_bf16 v[60:63], v[140:143], v[164:167], v[60:63]
  ds_read_b64_tr_b16 v[108:109], v8 offset:12288
  s_add_u32 m0, s64, 12288
  v_mfma_f32_16x16x32_bf16 v[64:67], v[144:147], v[152:155], v[64:67]
  buffer_load_dwordx4 v2, s[44:47], s61 offen lds
  ds_read_b64_tr_b16 v[110:111], v8 offset:12800
  s_sub_u32 s66, s66, s73
  v_mfma_f32_16x16x32_bf16 v[68:71], v[144:147], v[156:159], v[68:71]
  ds_read_b64_tr_b16 v[112:113], v8 offset:16384
  v_mfma_f32_16x16x32_bf16 v[72:75], v[144:147], v[160:163], v[72:75]
  ds_read_b64_tr_b16 v[114:115], v8 offset:16896
  v_mfma_f32_16x16x32_bf16 v[76:79], v[144:147], v[164:167], v[76:79]
  v_add_u32 v8, s67, v5
  s_add_u32 m0, s64, 16384
  v_mfma_f32_16x16x32_bf16 v[80:83], v[148:151], v[152:155], v[80:83]
  buffer_load_dwordx4 v2, s[48:51], s61 offen lds
  v_add_u32 v9, s68, v7
  v_mfma_f32_16x16x32_bf16 v[84:87], v[148:151], v[156:159], v[84:87]
  v_mfma_f32_16x16x32_bf16 v[88:91], v[148:151], v[160:163], v[88:91]
  v_mfma_f32_16x16x32_bf16 v[92:95], v[148:151], v[164:167], v[92:95]
  s_add_u32 s69, s69, 1
  s_bitcmp1_b32 94, s69
  s_cbranch_scc0 k_l1
  s_branch k_side
k_l0pre:
  s_waitcnt vmcnt(11)
  s_barrier
  ds_read_b128 v[116:119], v9 offset:0
  ds_read_b64_tr_b16 v[96:97], v8 offset:0
  ds_read_b64_tr_b16 v[98:99], v8 offset:512
  ds_read_b128 v[120:123], v9 offset:2048
  ds_read_b128 v[124:127], v9 offset:4096
  ds_read_b128 v[128:131], v9 offset:6144
  ds_read_b64_tr_b16 v[100:101], v8 offset:4096
  ds_read_b64_tr_b16 v[102:103], v8 offset:4608
  ds_read_b64_tr_b16 v[104:105], v8 offset:8192
  ds_read_b64_tr_b16 v[106:107], v8 offset:8704
  ds_read_b64_tr_b16 v[108:109], v8 offset:12288
  ds_read_b64_tr_b16 v[110:111], v8 offset:12800
  ds_read_b64_tr_b16 v[112:113], v8 offset:16384
  ds_read_b64_tr_b16 v[114:115], v8 offset:16896
  s_add_u32 s67, s67, 20480
  s_cmp_ge_u32 s67, 102400
  s_cselect_b32 s67, 0, s67
  v_add_u32 v8, s67, v5
  v_add_u32 v9, s68, v7
  s_waitcnt lgkmcnt(0) vmcnt(6)
  s_barrier
  v_mfma_f32_16x16x32_bf16 v[16:19], v[96:99], v[116:119], 0
  s_add_u32 m0, s64, 0
  s_add_u32 s67, s67, 20480
  s_lshl_b32 s78, s70, 4
  s_add_u32 s78, s78, s71
  s_lshl_b32 s79, s78, 5
  v_mfma_f32_16x16x32_bf16 v[20:23], v[96:99], v[120:123], 0
  buffer_load_dwordx4 v1, s[32:35], s60 offen lds
  ds_read_b128 v[152:155], v9 offset:0
  s_lshl_b32 s78, s78, 7
  s_add_u32 s79, s79, 22118400
  v_mfma_f32_16x16x32_bf16 v[24:27], v[96:99], v[124:127], 0
  ds_read_b64_tr_b16 v[132:133], v8 offset:0
  s_add_u32 m0, s64, 4096
  v_mov_b32 v245, s79
  s_add_u32 s78, s78, 22085632
  v_writelane_b32 v245, s78, 2
  v_mfma_f32_16x16x32_bf16 v[28:31], v[96:99], v[128:131], 0
  buffer_load_dwordx4 v2, s[36:39], s61 offen lds
  ds_read_b64_tr_b16 v[134:135], v8 offset:512
  s_cmp_ge_u32 s67, 102400
  s_cselect_b32 s67, 0, s67
  s_lshr_b32 s78, s2, 3
  s_lshl_b32 s78, s78, 5
  v_mfma_f32_16x16x32_bf16 v[32:35], v[100:103], v[116:119], 0
  ds_read_b128 v[156:159], v9 offset:2048
  s_add_u32 m0, s64, 8192
  s_and_b32 s79, s2, 7
  s_add_u32 s78, s78, s79
  v_mfma_f32_16x16x32_bf16 v[36:39], v[100:103], v[120:123], 0
  buffer_load_dwordx4 v2, s[40:43], s61 offen lds
  ds_read_b128 v[160:163], v9 offset:4096
  s_lshl_b32 s78, s78, 2
  s_add_u32 s78, s78, 22126592
  v_writelane_b32 v245, s78, 1
  v_mfma_f32_16x16x32_bf16 v[40:43], v[100:103], v[124:127], 0
  ds_read_b128 v[164:167], v9 offset:6144
  s_add_u32 m0, s64, 12288
  s_add_u32 s78, s78, 4096
  v_writelane_b32 v245, s78, 3
  v_mfma_f32_16x16x32_bf16 v[44:47], v[100:103], v[128:131], 0
  buffer_load_dwordx4 v2, s[44:47], s61 offen lds
  ds_read_b64_tr_b16 v[136:137], v8 offset:4096
  s_add_u32 s68, s68, 16384
  s_mul_i32 s77, s2, 3
  s_sub_u32 s83, s26, 4
  s_add_u32 s77, s77, s83
  v_mfma_f32_16x16x32_bf16 v[48:51], v[104:107], v[116:119], 0
  ds_read_b64_tr_b16 v[138:139], v8 offset:4608
  s_add_u32 m0, s64, 16384
  s_cmp_lt_u32 s83, 3
  s_cselect_b32 s77, s77, 1000
  s_mul_i32 s78, s77, 6554
  v_mfma_f32_16x16x32_bf16 v[52:55], v[104:107], v[120:123], 0
  buffer_load_dwordx4 v2, s[48:51], s61 offen lds
  ds_read_b64_tr_b16 v[140:141], v8 offset:8192
  s_lshr_b32 s78, s78, 16
  s_mul_i32 s79, s78, 10
  v_mfma_f32_16x16x32_bf16 v[56:59], v[104:107], v[124:127], 0
  ds_read_b64_tr_b16 v[142:143], v8 offset:8704
  s_cmp_ge_u32 s68, 151552
  s_cselect_b32 s68, 102400, s68
  s_sub_u32 s79, s77, s79
  s_lshl_b32 s79, s79, 7
  s_lshr_b32 s80, s78, 2
  v_mfma_f32_16x16x32_bf16 v[60:63], v[104:107], v[128:131], 0
  ds_read_b64_tr_b16 v[144:145], v8 offset:12288
  s_add_u32 s90, s90, 1
  s_xor_b32 s73, s90, s92
  s_mul_i32 s60, s73, s62
  s_mul_i32 s61, s73, s63
  s_add_u32 s60, s60, s88
  s_add_u32 s61, s61, s89
  s_add_u32 s64, s64, 40960
  s_cmp_ge_u32 s64, 102400
  s_cselect_b32 s73, 102400, 0
  s_sub_u32 s64, s64, s73
  s_lshl_b32 s80, s80, 7
  s_and_b32 s81, s78, 3
  v_mfma_f32_16x16x32_bf16 v[64:67], v[108:111], v[116:119], 0
  ds_read_b64_tr_b16 v[146:147], v8 offset:12800
  s_add_u32 m0, s66, 0
  s_lshl_b32 s81, s81, 4
  s_add_u32 s80, s80, s81
  s_sub_u32 s81, s78, 48
  v_mfma_f32_16x16x32_bf16 v[68:71], v[108:111], v[120:123], 0
  buffer_load_dwordx4 v3, s[28:31], s65 offen lds
  ds_read_b64_tr_b16 v[148:149], v8 offset:16384
  s_lshl_b32 s81, s81, 5
  s_cmp_lt_u32 s78, 48
  s_cselect_b32 s80, s80, s81
  s_mov_b32 s81, 20480
  s_mov_b32 s86, 819200
  s_cselect_b32 s81, 81920, s81
  s_cselect_b32 s84, s16, s8
  s_cselect_b32 s85, s17, s9
  s_cselect_b32 s86, 1966080, s86
  v_mfma_f32_16x16x32_bf16 v[72:75], v[108:111], v[124:127], 0
  ds_read_b64_tr_b16 v[150:151], v8 offset:16896
  s_mov_b32 s87, 0x20000
  s_mul_i32 s80, s80, 1280
  v_mfma_f32_16x16x32_bf16 v[76:79], v[108:111], v[128:131], 0
  v_add_u32 v8, s67, v5
  s_add_u32 m0, s66, 1024
  s_add_u32 s80, s80, s79
  v_mul_u32_u24 v178, 1280, v168
  v_lshl_add_u32 v178, v169, 4, v178
  v_mfma_f32_16x16x32_bf16 v[80:83], v[112:115], v[116:119], 0
  buffer_load_dwordx4 v4, s[28:31], s65 offen lds
  v_add_u32 v9, s68, v6
  s_lshl_b32 s79, s83, 12
  s_add_u32 s79, s79, 151552
  v_mfma_f32_16x16x32_bf16 v[84:87], v[112:115], v[120:123], 0
  s_add_u32 s91, s91, 1
  s_xor_b32 s73, s91, s92
  s_lshl_b32 s65, s73, 7
  s_add_u32 s66, s66, 16384
  s_cmp_ge_u32 s66, 151552
  s_cselect_b32 s73, 49152, 0
  s_sub_u32 s66, s66, s73
  v_lshrrev_b32 v177, 2, v0
  v_lshlrev_b32 v177, 7, v177
  v_and_b32 v176, 3, v0
  v_mfma_f32_16x16x32_bf16 v[88:91], v[112:115], v[124:127], 0
  v_lshl_add_u32 v177, v176, 3, v177
  v_add_u32 v177, s79, v177
  v_mfma_f32_16x16x32_bf16 v[92:95], v[112:115], v[128:131], 0
  s_lshl_b32 s95, s77, 12
  s_add_u32 s95, s95, 18874368
  s_waitcnt lgkmcnt(0) vmcnt(7)
  s_barrier
  v_mfma_f32_16x16x32_bf16 v[16:19], v[132:135], v[152:155], v[16:19]
  s_add_u32 m0, s64, 0
  s_add_u32 s67, s67, 20480
  v_mov_b32 v179, 0
  v_lshlrev_b32 v180, 16, v184
  v_lshlrev_b32 v181, 16, v190
  v_fmac_f32 v179, v180, v181
  v_mfma_f32_16x16x32_bf16 v[20:23], v[132:135], v[156:159], v[20:23]
  buffer_load_dwordx4 v1, s[32:35], s60 offen lds
  ds_read_b128 v[116:119], v9 offset:0
  v_and_b32 v182, 0xffff0000, v184
  v_and_b32 v183, 0xffff0000, v190
  v_fmac_f32 v179, v182, v183
  v_mfma_f32_16x16x32_bf16 v[24:27], v[132:135], v[160:163], v[24:27]
  ds_read_b64_tr_b16 v[96:97], v8 offset:0
  s_add_u32 m0, s64, 4096
  v_lshlrev_b32 v180, 16, v185
  v_lshlrev_b32 v181, 16, v191
  v_fmac_f32 v179, v180, v181
  v_mfma_f32_16x16x32_bf16 v[28:31], v[132:135], v[164:167], v[28:31]
  buffer_load_dwordx4 v2, s[36:39], s61 offen lds
  ds_read_b64_tr_b16 v[98:99], v8 offset:512
  v_and_b32 v182, 0xffff0000, v185
  v_and_b32 v183, 0xffff0000, v191
  v_fmac_f32 v179, v182, v183
  v_mfma_f32_16x16x32_bf16 v[32:35], v[136:139], v[152:155], v[32:35]
  ds_read_b128 v[120:123], v9 offset:2048
  s_add_u32 m0, s64, 8192
  v_lshlrev_b32 v180, 16, v186
  v_lshlrev_b32 v181, 16, v192
  v_fmac_f32 v179, v180, v181
  v_mfma_f32_16x16x32_bf16 v[36:39], v[136:139], v[156:159], v[36:39]
  buffer_load_dwordx4 v2, s[40:43], s61 offen lds
  ds_read_b128 v[124:127], v9 offset:4096
  v_and_b32 v182, 0xffff0000, v186
  v_and_b32 v183, 0xffff0000, v192
  v_fmac_f32 v179, v182, v183
  v_mfma_f32_16x16x32_bf16 v[40:43], v[136:139], v[160:163], v[40:43]
  ds_read_b128 v[128:131], v9 offset:6144
  s_add_u32 m0, s64, 12288
  v_lshlrev_b32 v180, 16, v187
  v_lshlrev_b32 v181, 16, v193
  v_fmac_f32 v179, v180, v181
  v_mfma_f32_16x16x32_bf16 v[44:47], v[136:139], v[164:167], v[44:47]
  buffer_load_dwordx4 v2, s[44:47], s61 offen lds
  ds_read_b64_tr_b16 v[100:101], v8 offset:4096
  s_cmp_ge_u32 s67, 102400
  s_cselect_b32 s67, 0, s67
  v_and_b32 v182, 0xffff0000, v187
  v_and_b32 v183, 0xffff0000, v193
  v_fmac_f32 v179, v182, v183
  v_mfma_f32_16x16x32_bf16 v[48:51], v[140:143], v[152:155], v[48:51]
  ds_read_b64_tr_b16 v[102:103], v8 offset:4608
  v_lshlrev_b32 v180, 16, v188
  v_lshlrev_b32 v181, 16, v194
  v_fmac_f32 v179, v180, v181
  v_mfma_f32_16x16x32_bf16 v[52:55], v[140:143], v[156:159], v[52:55]
  ds_read_b64_tr_b16 v[104:105], v8 offset:8192
  s_add_u32 m0, s64, 16384
  v_and_b32 v182, 0xffff0000, v188
  v_and_b32 v183, 0xffff0000, v194
  v_fmac_f32 v179, v182, v183
  v_mfma_f32_16x16x32_bf16 v[56:59], v[140:143], v[160:163], v[56:59]
  buffer_load_dwordx4 v2, s[48:51], s61 offen lds
  ds_read_b64_tr_b16 v[106:107], v8 offset:8704
  s_nop 0
  v_add_f32_dpp v179, v179, v179 row_shr:1 bound_ctrl:0
  v_mfma_f32_16x16x32_bf16 v[60:63], v[140:143], v[164:167], v[60:63]
  ds_read_b64_tr_b16 v[108:109], v8 offset:12288
  s_nop 0
  v_add_f32_dpp v179, v179, v179 row_shr:2 bound_ctrl:0
  v_mfma_f32_16x16x32_bf16 v[64:67], v[144:147], v[152:155], v[64:67]
  ds_read_b64_tr_b16 v[110:111], v8 offset:12800
  s_add_u32 s90, s90, 1
  s_xor_b32 s73, s90, s92
  s_mul_i32 s60, s73, s62
  s_mul_i32 s61, s73, s63
  s_add_u32 s60, s60, s88
  s_add_u32 s61, s61, s89
  s_add_u32 s64, s64, 40960
  s_cmp_ge_u32 s64, 102400
  s_cselect_b32 s73, 102400, 0
  s_sub_u32 s64, s64, s73
  s_nop 0
  v_add_f32_dpp v179, v179, v179 row_shr:4 bound_ctrl:0
  v_mfma_f32_16x16x32_bf16 v[68:71], v[144:147], v[156:159], v[68:71]
  ds_read_b64_tr_b16 v[112:113], v8 offset:16384
  s_nop 0
  v_add_f32_dpp v179, v179, v179 row_shr:8 bound_ctrl:0
  v_mfma_f32_16x16x32_bf16 v[72:75], v[144:147], v[160:163], v[72:75]
  ds_read_b64_tr_b16 v[114:115], v8 offset:16896
  s_add_u32 m0, s66, 0
  s_nop 0
  v_add_f32_dpp v179, v179, v179 row_bcast:15 row_mask:0xa
  v_mfma_f32_16x16x32_bf16 v[76:79], v[144:147], v[164:167], v[76:79]
  buffer_load_dwordx4 v3, s[28:31], s65 offen lds
  v_add_u32 v8, s67, v5
  s_nop 0
  v_add_f32_dpp v179, v179, v179 row_bcast:31 row_mask:0xc
  v_mfma_f32_16x16x32_bf16 v[80:83], v[148:151], v[152:155], v[80:83]
  v_add_u32 v9, s68, v7
  s_add_u32 m0, s66, 1024
  v_mul_f32 v179, 0xbfb8aa3b, v179
  v_exp_f32 v179, v179
  s_lshl_b32 s78, s70, 4
  s_add_u32 s78, s78, s71
  v_mfma_f32_16x16x32_bf16 v[84:87], v[148:151], v[156:159], v[84:87]
  buffer_load_dwordx4 v4, s[28:31], s65 offen lds
  v_add_f32 v179, 1.0, v179
  v_rcp_f32 v179, v179
  s_lshl_b32 s78, s78, 5
  s_add_u32 s78, s78, s26
  v_mfma_f32_16x16x32_bf16 v[88:91], v[148:151], v[160:163], v[88:91]
  s_lshl_b32 s78, s78, 2
  s_add_u32 s78, s78, 22019844
  v_mfma_f32_16x16x32_bf16 v[92:95], v[148:151], v[164:167], v[92:95]
  s_mov_b32 exec_lo, 0
  s_brev_b32 exec_hi, 1
  buffer_store_dword v179, v248, s[52:55], s78 offen sc1
  s_mov_b64 exec, -1
  s_mov_b32 s69, 1
  s_branch k_side
k_l0:
  s_waitcnt lgkmcnt(0) vmcnt(9)
  s_barrier
  v_mfma_f32_16x16x32_bf16 v[16:19], v[96:99], v[116:119], v[16:19]
  s_add_u32 s67, s67, 20480
  v_mfma_f32_16x16x32_bf16 v[20:23], v[96:99], v[120:123], v[20:23]
  ds_read_b128 v[152:155], v9 offset:0
  s_add_u32 m0, s64, 0
  s_cmp_ge_u32 s67, 102400
  s_cselect_b32 s67, 0, s67
  v_mfma_f32_16x16x32_bf16 v[24:27], v[96:99], v[124:127], v[24:27]
  buffer_load_dwordx4 v1, s[32:35], s60 offen lds
  ds_read_b64_tr_b16 v[132:133], v8 offset:0
  s_add_u32 s68, s68, 16384
  v_mfma_f32_16x16x32_bf16 v[28:31], v[96:99], v[128:131], v[28:31]
  ds_read_b64_tr_b16 v[134:135], v8 offset:512
  v_mfma_f32_16x16x32_bf16 v[32:35], v[100:103], v[116:119], v[32:35]
  ds_read_b128 v[156:159], v9 offset:2048
  s_add_u32 m0, s64, 4096
  s_cmp_ge_u32 s68, 151552
  s_cselect_b32 s68, 102400, s68
  v_mfma_f32_16x16x32_bf16 v[36:39], v[100:103], v[120:123], v[36:39]
  buffer_load_dwordx4 v2, s[36:39], s61 offen lds
  ds_read_b128 v[160:163], v9 offset:4096
  s_add_u32 s91, s91, 1
  v_mfma_f32_16x16x32_bf16 v[40:43], v[100:103], v[124:127], v[40:43]
  ds_read_b128 v[164:167], v9 offset:6144
  v_mfma_f32_16x16x32_bf16 v[44:47], v[100:103], v[128:131], v[44:47]
  ds_read_b64_tr_b16 v[136:137], v8 offset:4096
  s_xor_b32 s73, s91, s92
  v_mfma_f32_16x16x32_bf16 v[48:51], v[104:107], v[116:119], v[48:51]
  ds_read_b64_tr_b16 v[138:139], v8 offset:4608
  s_add_u32 m0, s64, 8192
  s_lshl_b32 s65, s73, 7
  v_mfma_f32_16x16x32_bf16 v[52:55], v[104:107], v[120:123], v[52:55]
  buffer_load_dwordx4 v2, s[40:43], s61 offen lds
  ds_read_b64_tr_b16 v[140:141], v8 offset:8192
  s_add_u32 s66, s66, 16384
  v_mfma_f32_16x16x32_bf16 v[56:59], v[104:107], v[124:127], v[56:59]
  ds_read_b64_tr_b16 v[142:143], v8 offset:8704
  v_mfma_f32_16x16x32_bf16 v[60:63], v[104:107], v[128:131], v[60:63]
  ds_read_b64_tr_b16 v[144:145], v8 offset:12288
  s_add_u32 m0, s64, 12288
  s_cmp_ge_u32 s66, 151552
  s_cselect_b32 s73, 49152, 0
  v_mfma_f32_16x16x32_bf16 v[64:67], v[108:111], v[116:119], v[64:67]
  buffer_load_dwordx4 v2, s[44:47], s61 offen lds
  ds_read_b64_tr_b16 v[146:147], v8 offset:12800
  s_sub_u32 s66, s66, s73
  v_mfma_f32_16x16x32_bf16 v[68:71], v[108:111], v[120:123], v[68:71]
  ds_read_b64_tr_b16 v[148:149], v8 offset:16384
  v_mfma_f32_16x16x32_bf16 v[72:75], v[108:111], v[124:127], v[72:75]
  ds_read_b64_tr_b16 v[150:151], v8 offset:16896
  v_mfma_f32_16x16x32_bf16 v[76:79], v[108:111], v[128:131], v[76:79]
  v_add_u32 v8, s67, v5
  s_add_u32 m0, s64, 16384
  v_mfma_f32_16x16x32_bf16 v[80:83], v[112:115], v[116:119], v[80:83]
  buffer_load_dwordx4 v2, s[48:51], s61 offen lds
  v_add_u32 v9, s68, v6
  v_mfma_f32_16x16x32_bf16 v[84:87], v[112:115], v[120:123], v[84:87]
  v_mfma_f32_16x16x32_bf16 v[88:91], v[112:115], v[124:127], v[88:91]
  v_mfma_f32_16x16x32_bf16 v[92:95], v[112:115], v[128:131], v[92:95]
  s_cmp_eq_u32 s69, 7
  s_cbranch_scc1 k_tail
  s_waitcnt lgkmcnt(0) vmcnt(12)
  s_barrier
  v_mfma_f32_16x16x32_bf16 v[16:19], v[132:135], v[152:155], v[16:19]
  s_add_u32 s67, s67, 20480
  v_mfma_f32_16x16x32_bf16 v[20:23], v[132:135], v[156:159], v[20:23]
  ds_read_b128 v[116:119], v9 offset:0
  s_cmp_ge_u32 s67, 102400
  s_cselect_b32 s67, 0, s67
  v_mfma_f32_16x16x32_bf16 v[24:27], v[132:135], v[160:163], v[24:27]
  ds_read_b64_tr_b16 v[96:97], v8 offset:0
  s_add_u32 s90, s90, 1
  v_mfma_f32_16x16x32_bf16 v[28:31], v[132:135], v[164:167], v[28:31]
  ds_read_b64_tr_b16 v[98:99], v8 offset:512
  s_xor_b32 s73, s90, s92
  v_mfma_f32_16x16x32_bf16 v[32:35], v[136:139], v[152:155], v[32:35]
  ds_read_b128 v[120:123], v9 offset:2048
  v_mfma_f32_16x16x32_bf16 v[36:39], v[136:139], v[156:159], v[36:39]
  ds_read_b128 v[124:127], v9 offset:4096
  s_mul_i32 s60, s73, s62
  v_mfma_f32_16x16x32_bf16 v[40:43], v[136:139], v[160:163], v[40:43]
  ds_read_b128 v[128:131], v9 offset:6144
  s_add_u32 m0, s66, 0
  s_mul_i32 s61, s73, s63
  v_mfma_f32_16x16x32_bf16 v[44:47], v[136:139], v[164:167], v[44:47]
  buffer_load_dwordx4 v3, s[28:31], s65 offen lds
  ds_read_b64_tr_b16 v[100:101], v8 offset:4096
  s_add_u32 s60, s60, s88
  v_mfma_f32_16x16x32_bf16 v[48:51], v[140:143], v[152:155], v[48:51]
  ds_read_b64_tr_b16 v[102:103], v8 offset:4608
  s_add_u32 s61, s61, s89
  v_mfma_f32_16x16x32_bf16 v[52:55], v[140:143], v[156:159], v[52:55]
  ds_read_b64_tr_b16 v[104:105], v8 offset:8192
  v_mfma_f32_16x16x32_bf16 v[56:59], v[140:143], v[160:163], v[56:59]
  ds_read_b64_tr_b16 v[106:107], v8 offset:8704
  s_add_u32 s64, s64, 40960
  v_mfma_f32_16x16x32_bf16 v[60:63], v[140:143], v[164:167], v[60:63]
  ds_read_b64_tr_b16 v[108:109], v8 offset:12288
  s_cmp_ge_u32 s64, 102400
  s_cselect_b32 s73, 102400, 0
  v_mfma_f32_16x16x32_bf16 v[64:67], v[144:147], v[152:155], v[64:67]
  ds_read_b64_tr_b16 v[110:111], v8 offset:12800
  s_sub_u32 s64, s64, s73
  v_mfma_f32_16x16x32_bf16 v[68:71], v[144:147], v[156:159], v[68:71]
  ds_read_b64_tr_b16 v[112:113], v8 offset:16384
  s_add_u32 m0, s66, 1024
  v_mfma_f32_16x16x32_bf16 v[72:75], v[144:147], v[160:163], v[72:75]
  buffer_load_dwordx4 v4, s[28:31], s65 offen lds
  ds_read_b64_tr_b16 v[114:115], v8 offset:16896
  v_mfma_f32_16x16x32_bf16 v[76:79], v[144:147], v[164:167], v[76:79]
  v_add_u32 v8, s67, v5
  v_mfma_f32_16x16x32_bf16 v[80:83], v[148:151], v[152:155], v[80:83]
  v_add_u32 v9, s68, v7
  v_mfma_f32_16x16x32_bf16 v[84:87], v[148:151], v[156:159], v[84:87]
  v_mfma_f32_16x16x32_bf16 v[88:91], v[148:151], v[160:163], v[88:91]
  v_mfma_f32_16x16x32_bf16 v[92:95], v[148:151], v[164:167], v[92:95]
  s_add_u32 s69, s69, 1
  s_bitcmp1_b32 94, s69
  s_cbranch_scc0 k_l0
k_side:
  s_cmp_eq_u32 s69, 1
  s_cbranch_scc0 k_side1
  s_cmp_eq_u32 s26, 3
  s_cselect_b32 s78, s2, 1
  s_cmp_eq_u32 s78, 0
  s_cbranch_scc0 k_nosig
  s_mov_b64 exec, 1
  buffer_store_dword v246, v248, s[56:59], 0 offen sc1
  s_mov_b64 exec, -1
k_nosig:
  s_cmp_ge_u32 s77, 680
  s_cbranch_scc1 k_back
  s_add_u32 m0, s79, 0
  s_nop 0
  buffer_load_dwordx4 v178, s[84:87], s80 offen lds
  s_add_u32 m0, s79, 1024
  s_add_u32 s82, s80, 10240
  buffer_load_dwordx4 v178, s[84:87], s82 offen lds
  s_add_u32 m0, s79, 2048
  s_add_u32 s80, s80, s81
  buffer_load_dwordx4 v178, s[84:87], s80 offen lds
  s_add_u32 m0, s79, 3072
  s_add_u32 s82, s80, 10240
  buffer_load_dwordx4 v178, s[84:87], s82 offen lds
  s_branch k_back
k_side1:
  s_cmp_eq_u32 s69, 2
  s_cbranch_scc0 k_side2
  s_cmp_ge_u32 s77, 680
  s_cbranch_scc1 k_back
  s_waitcnt vmcnt(7)
  ds_read_b64_tr_b16 v[188:189], v177 offset:0
  ds_read_b64_tr_b16 v[190:191], v177 offset:2048
  ds_read_b64_tr_b16 v[192:193], v177 offset:32
  ds_read_b64_tr_b16 v[194:195], v177 offset:2080
  ds_read_b64_tr_b16 v[196:197], v177 offset:64
  ds_read_b64_tr_b16 v[198:199], v177 offset:2112
  ds_read_b64_tr_b16 v[200:201], v177 offset:96
  ds_read_b64_tr_b16 v[202:203], v177 offset:2144
  s_waitcnt lgkmcnt(0)
  buffer_store_dwordx4 v[188:191], v244, s[52:55], s95 offen offset:0 sc1
  buffer_store_dwordx4 v[192:195], v244, s[52:55], s95 offen offset:1024 sc1
  buffer_store_dwordx4 v[196:199], v244, s[52:55], s95 offen offset:2048 sc1
  buffer_store_dwordx4 v[200:203], v244, s[52:55], s95 offen offset:3072 sc1
  s_branch k_back
k_side2:
  s_cmp_eq_u32 s26, 3
  s_cbranch_scc0 k_back
  s_cmp_eq_u32 s69, 4
  s_cbranch_scc1 k_side4
  s_cmp_eq_u32 s69, 6
  s_cbranch_scc1 k_side6
  v_mov_b32 v208, 0
  v_lshrrev_b32 v209, 1, v0
  v_lshlrev_b32 v209, 3, v209
  v_and_or_b32 v209, v0, 1, v209
  v_lshlrev_b32 v209, 4, v209
  buffer_load_dword v247, v208, s[56:59], 0 offen sc1
  s_branch k_back
k_side4:
  s_waitcnt vmcnt(7)
  s_mov_b32 s98, 0
  s_branch spin1c
spin1:
  buffer_load_dword v247, v208, s[56:59], 0 offen sc1
  s_waitcnt vmcnt(0)
spin1c:
  v_cmp_ne_u32 vcc, 1, v247
  s_add_u32 s98, s98, 1
  s_cbranch_vccz spin1d
  s_cmp_lt_u32 s98, 0x40000
  s_cbranch_scc1 spin1
spin1d:
  s_mov_b64 exec, 8
  buffer_store_dword v246, v245, s[52:55], 0 offen sc1
  s_mov_b64 exec, -1
  s_branch k_back
k_side6:
  s_mov_b32 s99, 22130688
  buffer_load_dwordx4 v[210:213], v209, s[52:55], s99 offen sc1
k_back:
  s_cmp_eq_u32 s27, 0
  s_cbranch_scc1 k_l0
  s_branch k_l1
k_tail:
  s_and_b32 s34, s2, 7
  s_lshr_b32 s35, s2, 3
  s_lshr_b32 s32, s34, 1
  s_lshl_b32 s32, s32, 3
  s_and_b32 s36, s35, 7
  s_add_u32 s32, s32, s36
  s_and_b32 s33, s34, 1
  s_lshl_b32 s33, s33, 2
  s_lshr_b32 s35, s35, 3
  s_add_u32 s33, s33, s35
  s_and_b32 s34, s26, 3
  s_lshl_b32 s36, s32, 1
  s_add_u32 s36, s36, s27
  s_lshl_b32 s48, s36, 7
  s_mul_i32 s38, s36, 136
  s_add_u32 s38, s38, s34
  s_lshl_b32 s38, s38, 10
  s_add_u32 s38, s38, 8388608
  s_lshl_b32 s36, s34, 3
  s_add_u32 s36, s36, s33
  s_mul_i32 s40, s36, 5120
  s_add_u32 s40, s40, 18874368
  s_mul_i32 s41, s34, 5120
  s_xor_b32 s45, s27, 1
  s_mov_b32 s47, s71
  v_add_u32 v249, s41, v244
  v_add_u32 v250, 61440, v249
  v_add_u32 v251, 122880, v249
  s_and_b32 s73, s26, 3
  s_lshl_b32 s75, s72, 2
  s_add_u32 s75, s75, s73
  s_mul_i32 s75, s75, 66560
  s_lshl_b32 s76, s70, 10
  s_add_u32 s75, s75, s76
  s_lshl_b32 s76, s27, 9
  s_add_u32 s75, s75, s76
  v_lshrrev_b32 v184, 4, v0
  v_mul_u32_u24 v184, 16640, v184
  v_and_b32 v185, 15, v0
  v_lshl_add_u32 v184, v185, 4, v184
  s_cmp_lt_u32 s72, 10
  s_cselect_b32 s76, 0x3ea52b5c, 1.0
  s_and_b32 s98, s71, 7
  s_cmp_eq_u32 s98, 1
  s_cselect_b32 s75, 0x40000000, s75
  s_mul_i32 s50, s45, 163840
  s_add_u32 s50, s50, s40
  s_and_b32 s51, s45, 7
  s_mul_i32 s51, s51, 20480
  s_add_u32 s51, s51, s41
  s_cmp_eq_u32 s26, 3
  s_cbranch_scc0 k_rdy
  s_waitcnt vmcnt(12)
  s_mov_b32 s98, 0
  s_mov_b32 s99, 22130688
k_rdl:
  v_and_b32 v210, v210, v211
  v_and_b32 v212, v212, v213
  v_and_b32 v210, v210, v212
  v_cmp_ne_u32 vcc, 1, v210
  s_add_u32 s98, s98, 1
  s_cbranch_vccz k_rdy
  buffer_load_dwordx4 v[210:213], v209, s[52:55], s99 offen sc1
  s_waitcnt vmcnt(0)
  s_cmp_lt_u32 s98, 0x40000
  s_cbranch_scc1 k_rdl
k_rdy:
  s_cmp_eq_u32 s27, 0
  s_cbranch_scc1 k_todd0
  s_branch k_todd1
k_teven1:
  s_waitcnt lgkmcnt(0)
  s_barrier
  v_mfma_f32_16x16x32_bf16 v[16:19], v[96:99], v[116:119], v[16:19]
  s_add_u32 s67, s67, 20480
  v_mfma_f32_16x16x32_bf16 v[20:23], v[96:99], v[120:123], v[20:23]
  ds_read_b128 v[152:155], v9 offset:0
  s_cmp_ge_u32 s67, 102400
  s_cselect_b32 s67, 0, s67
  v_mfma_f32_16x16x32_bf16 v[24:27], v[96:99], v[124:127], v[24:27]
  ds_read_b64_tr_b16 v[132:133], v8 offset:0
  v_mfma_f32_16x16x32_bf16 v[28:31], v[96:99], v[128:131], v[28:31]
  ds_read_b64_tr_b16 v[134:135], v8 offset:512
  s_add_u32 s68, s68, 16384
  v_mfma_f32_16x16x32_bf16 v[32:35], v[100:103], v[116:119], v[32:35]
  ds_read_b128 v[156:159], v9 offset:2048
  s_cmp_ge_u32 s68, 151552
  s_cselect_b32 s68, 102400, s68
  v_mfma_f32_16x16x32_bf16 v[36:39], v[100:103], v[120:123], v[36:39]
  ds_read_b128 v[160:163], v9 offset:4096
  v_mfma_f32_16x16x32_bf16 v[40:43], v[100:103], v[124:127], v[40:43]
  ds_read_b128 v[164:167], v9 offset:6144
  s_mul_i32 s50, s45, 163840
  v_mfma_f32_16x16x32_bf16 v[44:47], v[100:103], v[128:131], v[44:47]
  ds_read_b64_tr_b16 v[136:137], v8 offset:4096
  s_add_u32 s50, s50, s40
  v_mfma_f32_16x16x32_bf16 v[48:51], v[104:107], v[116:119], v[48:51]
  ds_read_b64_tr_b16 v[138:139], v8 offset:4608
  v_mfma_f32_16x16x32_bf16 v[52:55], v[104:107], v[120:123], v[52:55]
  ds_read_b64_tr_b16 v[140:141], v8 offset:8192
  s_and_b32 s51, s45, 7
  v_mfma_f32_16x16x32_bf16 v[56:59], v[104:107], v[124:127], v[56:59]
  ds_read_b64_tr_b16 v[142:143], v8 offset:8704
  s_mul_i32 s51, s51, 20480
  v_mfma_f32_16x16x32_bf16 v[60:63], v[104:107], v[128:131], v[60:63]
  ds_read_b64_tr_b16 v[144:145], v8 offset:12288
  v_mfma_f32_16x16x32_bf16 v[64:67], v[108:111], v[116:119], v[64:67]
  ds_read_b64_tr_b16 v[146:147], v8 offset:12800
  s_add_u32 s51, s51, s41
  v_mfma_f32_16x16x32_bf16 v[68:71], v[108:111], v[120:123], v[68:71]
  ds_read_b64_tr_b16 v[148:149], v8 offset:16384
  v_mfma_f32_16x16x32_bf16 v[72:75], v[108:111], v[124:127], v[72:75]
  ds_read_b64_tr_b16 v[150:151], v8 offset:16896
  v_mfma_f32_16x16x32_bf16 v[76:79], v[108:111], v[128:131], v[76:79]
  v_add_u32 v8, s67, v5
  v_mfma_f32_16x16x32_bf16 v[80:83], v[112:115], v[116:119], v[80:83]
  v_add_u32 v9, s68, v6
  v_mfma_f32_16x16x32_bf16 v[84:87], v[112:115], v[120:123], v[84:87]
  v_mfma_f32_16x16x32_bf16 v[88:91], v[112:115], v[124:127], v[88:91]
  v_mfma_f32_16x16x32_bf16 v[92:95], v[112:115], v[128:131], v[92:95]
  s_cmp_eq_u32 s69, 9
  s_cbranch_scc1 k_s1e
k_todd1:
  s_waitcnt lgkmcnt(0) vmcnt(5)
  s_barrier
  v_mfma_f32_16x16x32_bf16 v[16:19], v[132:135], v[152:155], v[16:19]
  s_add_u32 s67, s67, 20480
  v_mfma_f32_16x16x32_bf16 v[20:23], v[132:135], v[156:159], v[20:23]
  ds_read_b128 v[116:119], v9 offset:0
  s_mov_b32 m0, s51
  s_add_u32 s45, s45, 2
  v_mfma_f32_16x16x32_bf16 v[24:27], v[132:135], v[160:163], v[24:27]
  buffer_load_dwordx4 v244, s[52:55], s50 offen offset:0 sc1 lds
  ds_read_b64_tr_b16 v[96:97], v8 offset:0
  v_mfma_f32_16x16x32_bf16 v[28:31], v[132:135], v[164:167], v[28:31]
  ds_read_b64_tr_b16 v[98:99], v8 offset:512
  v_mfma_f32_16x16x32_bf16 v[32:35], v[136:139], v[152:155], v[32:35]
  ds_read_b128 v[120:123], v9 offset:2048
  v_mfma_f32_16x16x32_bf16 v[36:39], v[136:139], v[156:159], v[36:39]
  buffer_load_dwordx4 v244, s[52:55], s50 offen offset:1024 sc1 lds
  ds_read_b128 v[124:127], v9 offset:4096
  v_mfma_f32_16x16x32_bf16 v[40:43], v[136:139], v[160:163], v[40:43]
  ds_read_b128 v[128:131], v9 offset:6144
  v_mfma_f32_16x16x32_bf16 v[44:47], v[136:139], v[164:167], v[44:47]
  ds_read_b64_tr_b16 v[100:101], v8 offset:4096
  s_cmp_ge_u32 s67, 102400
  s_cselect_b32 s67, 0, s67
  v_mfma_f32_16x16x32_bf16 v[48:51], v[140:143], v[152:155], v[48:51]
  ds_read_b64_tr_b16 v[102:103], v8 offset:4608
  v_mfma_f32_16x16x32_bf16 v[52:55], v[140:143], v[156:159], v[52:55]
  buffer_load_dwordx4 v244, s[52:55], s50 offen offset:2048 sc1 lds
  ds_read_b64_tr_b16 v[104:105], v8 offset:8192
  v_mfma_f32_16x16x32_bf16 v[56:59], v[140:143], v[160:163], v[56:59]
  ds_read_b64_tr_b16 v[106:107], v8 offset:8704
  v_mfma_f32_16x16x32_bf16 v[60:63], v[140:143], v[164:167], v[60:63]
  ds_read_b64_tr_b16 v[108:109], v8 offset:12288
  v_mfma_f32_16x16x32_bf16 v[64:67], v[144:147], v[152:155], v[64:67]
  buffer_load_dwordx4 v244, s[52:55], s50 offen offset:3072 sc1 lds
  ds_read_b64_tr_b16 v[110:111], v8 offset:12800
  v_mfma_f32_16x16x32_bf16 v[68:71], v[144:147], v[156:159], v[68:71]
  ds_read_b64_tr_b16 v[112:113], v8 offset:16384
  v_mfma_f32_16x16x32_bf16 v[72:75], v[144:147], v[160:163], v[72:75]
  ds_read_b64_tr_b16 v[114:115], v8 offset:16896
  v_mfma_f32_16x16x32_bf16 v[76:79], v[144:147], v[164:167], v[76:79]
  v_add_u32 v8, s67, v5
  s_add_u32 m0, m0, 4096
  s_add_u32 s50, s50, 4096
  v_mfma_f32_16x16x32_bf16 v[80:83], v[148:151], v[152:155], v[80:83]
  buffer_load_dwordx4 v244, s[52:55], s50 offen offset:0 sc1 lds
  v_add_u32 v9, s68, v7
  v_mfma_f32_16x16x32_bf16 v[84:87], v[148:151], v[156:159], v[84:87]
  v_mfma_f32_16x16x32_bf16 v[88:91], v[148:151], v[160:163], v[88:91]
  v_mfma_f32_16x16x32_bf16 v[92:95], v[148:151], v[164:167], v[92:95]
  s_add_u32 s69, s69, 1
  s_branch k_teven1
k_teven0:
  s_waitcnt lgkmcnt(0) vmcnt(5)
  s_barrier
  v_mfma_f32_16x16x32_bf16 v[16:19], v[96:99], v[116:119], v[16:19]
  s_add_u32 s67, s67, 20480
  v_mfma_f32_16x16x32_bf16 v[20:23], v[96:99], v[120:123], v[20:23]
  ds_read_b128 v[152:155], v9 offset:0
  s_mov_b32 m0, s51
  s_add_u32 s45, s45, 2
  v_mfma_f32_16x16x32_bf16 v[24:27], v[96:99], v[124:127], v[24:27]
  buffer_load_dwordx4 v244, s[52:55], s50 offen offset:0 sc1 lds
  ds_read_b64_tr_b16 v[132:133], v8 offset:0
  v_mfma_f32_16x16x32_bf16 v[28:31], v[96:99], v[128:131], v[28:31]
  ds_read_b64_tr_b16 v[134:135], v8 offset:512
  s_cmp_ge_u32 s67, 102400
  s_cselect_b32 s67, 0, s67
  v_mfma_f32_16x16x32_bf16 v[32:35], v[100:103], v[116:119], v[32:35]
  ds_read_b128 v[156:159], v9 offset:2048
  v_mfma_f32_16x16x32_bf16 v[36:39], v[100:103], v[120:123], v[36:39]
  buffer_load_dwordx4 v244, s[52:55], s50 offen offset:1024 sc1 lds
  ds_read_b128 v[160:163], v9 offset:4096
  v_mfma_f32_16x16x32_bf16 v[40:43], v[100:103], v[124:127], v[40:43]
  ds_read_b128 v[164:167], v9 offset:6144
  v_mfma_f32_16x16x32_bf16 v[44:47], v[100:103], v[128:131], v[44:47]
  ds_read_b64_tr_b16 v[136:137], v8 offset:4096
  s_add_u32 s68, s68, 16384
  v_mfma_f32_16x16x32_bf16 v[48:51], v[104:107], v[116:119], v[48:51]
  ds_read_b64_tr_b16 v[138:139], v8 offset:4608
  v_mfma_f32_16x16x32_bf16 v[52:55], v[104:107], v[120:123], v[52:55]
  buffer_load_dwordx4 v244, s[52:55], s50 offen offset:2048 sc1 lds
  ds_read_b64_tr_b16 v[140:141], v8 offset:8192
  v_mfma_f32_16x16x32_bf16 v[56:59], v[104:107], v[124:127], v[56:59]
  ds_read_b64_tr_b16 v[142:143], v8 offset:8704
  s_cmp_ge_u32 s68, 151552
  s_cselect_b32 s68, 102400, s68
  v_mfma_f32_16x16x32_bf16 v[60:63], v[104:107], v[128:131], v[60:63]
  ds_read_b64_tr_b16 v[144:145], v8 offset:12288
  v_mfma_f32_16x16x32_bf16 v[64:67], v[108:111], v[116:119], v[64:67]
  buffer_load_dwordx4 v244, s[52:55], s50 offen offset:3072 sc1 lds
  ds_read_b64_tr_b16 v[146:147], v8 offset:12800
  v_mfma_f32_16x16x32_bf16 v[68:71], v[108:111], v[120:123], v[68:71]
  ds_read_b64_tr_b16 v[148:149], v8 offset:16384
  v_mfma_f32_16x16x32_bf16 v[72:75], v[108:111], v[124:127], v[72:75]
  ds_read_b64_tr_b16 v[150:151], v8 offset:16896
  v_mfma_f32_16x16x32_bf16 v[76:79], v[108:111], v[128:131], v[76:79]
  v_add_u32 v8, s67, v5
  s_add_u32 m0, m0, 4096
  s_add_u32 s50, s50, 4096
  v_mfma_f32_16x16x32_bf16 v[80:83], v[112:115], v[116:119], v[80:83]
  buffer_load_dwordx4 v244, s[52:55], s50 offen offset:0 sc1 lds
  v_add_u32 v9, s68, v6
  v_mfma_f32_16x16x32_bf16 v[84:87], v[112:115], v[120:123], v[84:87]
  v_mfma_f32_16x16x32_bf16 v[88:91], v[112:115], v[124:127], v[88:91]
  v_mfma_f32_16x16x32_bf16 v[92:95], v[112:115], v[128:131], v[92:95]
  s_cmp_eq_u32 s69, 9
  s_cbranch_scc1 k_s1e
k_todd0:
  s_waitcnt lgkmcnt(0) vmcnt(10)
  s_barrier
  v_mfma_f32_16x16x32_bf16 v[16:19], v[132:135], v[152:155], v[16:19]
  s_add_u32 s67, s67, 20480
  v_mfma_f32_16x16x32_bf16 v[20:23], v[132:135], v[156:159], v[20:23]
  ds_read_b128 v[116:119], v9 offset:0
  v_mfma_f32_16x16x32_bf16 v[24:27], v[132:135], v[160:163], v[24:27]
  ds_read_b64_tr_b16 v[96:97], v8 offset:0
  s_cmp_ge_u32 s67, 102400
  s_cselect_b32 s67, 0, s67
  v_mfma_f32_16x16x32_bf16 v[28:31], v[132:135], v[164:167], v[28:31]
  ds_read_b64_tr_b16 v[98:99], v8 offset:512
  v_mfma_f32_16x16x32_bf16 v[32:35], v[136:139], v[152:155], v[32:35]
  ds_read_b128 v[120:123], v9 offset:2048
  s_mul_i32 s50, s45, 163840
  v_mfma_f32_16x16x32_bf16 v[36:39], v[136:139], v[156:159], v[36:39]
  ds_read_b128 v[124:127], v9 offset:4096
  v_mfma_f32_16x16x32_bf16 v[40:43], v[136:139], v[160:163], v[40:43]
  ds_read_b128 v[128:131], v9 offset:6144
  s_add_u32 s50, s50, s40
  v_mfma_f32_16x16x32_bf16 v[44:47], v[136:139], v[164:167], v[44:47]
  ds_read_b64_tr_b16 v[100:101], v8 offset:4096
  v_mfma_f32_16x16x32_bf16 v[48:51], v[140:143], v[152:155], v[48:51]
  ds_read_b64_tr_b16 v[102:103], v8 offset:4608
  s_and_b32 s51, s45, 7
  v_mfma_f32_16x16x32_bf16 v[52:55], v[140:143], v[156:159], v[52:55]
  ds_read_b64_tr_b16 v[104:105], v8 offset:8192
  v_mfma_f32_16x16x32_bf16 v[56:59], v[140:143], v[160:163], v[56:59]
  ds_read_b64_tr_b16 v[106:107], v8 offset:8704
  s_mul_i32 s51, s51, 20480
  v_mfma_f32_16x16x32_bf16 v[60:63], v[140:143], v[164:167], v[60:63]
  ds_read_b64_tr_b16 v[108:109], v8 offset:12288
  v_mfma_f32_16x16x32_bf16 v[64:67], v[144:147], v[152:155], v[64:67]
  ds_read_b64_tr_b16 v[110:111], v8 offset:12800
  s_add_u32 s51, s51, s41
  v_mfma_f32_16x16x32_bf16 v[68:71], v[144:147], v[156:159], v[68:71]
  ds_read_b64_tr_b16 v[112:113], v8 offset:16384
  v_mfma_f32_16x16x32_bf16 v[72:75], v[144:147], v[160:163], v[72:75]
  ds_read_b64_tr_b16 v[114:115], v8 offset:16896
  v_mfma_f32_16x16x32_bf16 v[76:79], v[144:147], v[164:167], v[76:79]
  v_add_u32 v8, s67, v5
  v_mfma_f32_16x16x32_bf16 v[80:83], v[148:151], v[152:155], v[80:83]
  v_add_u32 v9, s68, v7
  v_mfma_f32_16x16x32_bf16 v[84:87], v[148:151], v[156:159], v[84:87]
  v_mfma_f32_16x16x32_bf16 v[88:91], v[148:151], v[160:163], v[88:91]
  v_mfma_f32_16x16x32_bf16 v[92:95], v[148:151], v[164:167], v[92:95]
  s_add_u32 s69, s69, 1
  s_branch k_teven0
k_s1e:
  s_waitcnt lgkmcnt(0)
  s_barrier
  s_cmp_eq_u32 s27, 0
  s_cbranch_scc1 k_ls0
  s_mov_b32 m0, s51
  s_add_u32 s45, s45, 2
  buffer_load_dwordx4 v244, s[52:55], s50 offen offset:0 sc1 lds
  buffer_load_dwordx4 v244, s[52:55], s50 offen offset:1024 sc1 lds
  buffer_load_dwordx4 v244, s[52:55], s50 offen offset:2048 sc1 lds
  buffer_load_dwordx4 v244, s[52:55], s50 offen offset:3072 sc1 lds
  s_add_u32 m0, m0, 4096
  s_add_u32 s50, s50, 4096
  buffer_load_dwordx4 v244, s[52:55], s50 offen offset:0 sc1 lds
k_ls0:
  s_cmp_lt_u32 s71, 12
  s_cbranch_scc1 k_eg
  v_mfma_f32_16x16x32_bf16 v[16:19], v[132:135], v[152:155], v[16:19]
  v_mfma_f32_16x16x32_bf16 v[20:23], v[132:135], v[156:159], v[20:23]
  v_mfma_f32_16x16x32_bf16 v[24:27], v[132:135], v[160:163], v[24:27]
  v_mfma_f32_16x16x32_bf16 v[28:31], v[132:135], v[164:167], v[28:31]
  v_mfma_f32_16x16x32_bf16 v[32:35], v[136:139], v[152:155], v[32:35]
  v_mfma_f32_16x16x32_bf16 v[36:39], v[136:139], v[156:159], v[36:39]
  v_mfma_f32_16x16x32_bf16 v[40:43], v[136:139], v[160:163], v[40:43]
  v_mfma_f32_16x16x32_bf16 v[44:47], v[136:139], v[164:167], v[44:47]
  v_mfma_f32_16x16x32_bf16 v[48:51], v[140:143], v[152:155], v[48:51]
  v_cvt_pk_bf16_f32 v188, v16, v17
  v_cvt_pk_bf16_f32 v189, v18, v19
  v_cvt_pk_bf16_f32 v190, v20, v21
  v_mfma_f32_16x16x32_bf16 v[52:55], v[140:143], v[156:159], v[52:55]
  v_cvt_pk_bf16_f32 v191, v22, v23
  buffer_store_dwordx4 v[188:191], v184, s[52:55], s75 offen offset:0 sc1
  v_mfma_f32_16x16x32_bf16 v[56:59], v[140:143], v[160:163], v[56:59]
  v_cvt_pk_bf16_f32 v192, v24, v25
  v_cvt_pk_bf16_f32 v193, v26, v27
  v_cvt_pk_bf16_f32 v194, v28, v29
  v_mfma_f32_16x16x32_bf16 v[60:63], v[140:143], v[164:167], v[60:63]
  v_cvt_pk_bf16_f32 v195, v30, v31
  buffer_store_dwordx4 v[192:195], v184, s[52:55], s75 offen offset:256 sc1
  v_mfma_f32_16x16x32_bf16 v[64:67], v[144:147], v[152:155], v[64:67]
  s_add_u32 s75, s75, 266240
  v_cvt_pk_bf16_f32 v196, v32, v33
  v_cvt_pk_bf16_f32 v197, v34, v35
  v_mfma_f32_16x16x32_bf16 v[68:71], v[144:147], v[156:159], v[68:71]
  v_cvt_pk_bf16_f32 v198, v36, v37
  v_cvt_pk_bf16_f32 v199, v38, v39
  buffer_store_dwordx4 v[196:199], v184, s[52:55], s75 offen offset:0 sc1
  v_mfma_f32_16x16x32_bf16 v[72:75], v[144:147], v[160:163], v[72:75]
  v_cvt_pk_bf16_f32 v200, v40, v41
  v_cvt_pk_bf16_f32 v201, v42, v43
  v_cvt_pk_bf16_f32 v202, v44, v45
  v_mfma_f32_16x16x32_bf16 v[76:79], v[144:147], v[164:167], v[76:79]
  v_cvt_pk_bf16_f32 v203, v46, v47
  buffer_store_dwordx4 v[200:203], v184, s[52:55], s75 offen offset:256 sc1
  v_mfma_f32_16x16x32_bf16 v[80:83], v[148:151], v[152:155], v[80:83]
  s_add_u32 s75, s75, 266240
  v_cvt_pk_bf16_f32 v188, v48, v49
  v_cvt_pk_bf16_f32 v189, v50, v51
  v_mfma_f32_16x16x32_bf16 v[84:87], v[148:151], v[156:159], v[84:87]
  v_cvt_pk_bf16_f32 v190, v52, v53
  v_cvt_pk_bf16_f32 v191, v54, v55
  buffer_store_dwordx4 v[188:191], v184, s[52:55], s75 offen offset:0 sc1
  v_mfma_f32_16x16x32_bf16 v[88:91], v[148:151], v[160:163], v[88:91]
  v_cvt_pk_bf16_f32 v192, v56, v57
  v_cvt_pk_bf16_f32 v193, v58, v59
  v_cvt_pk_bf16_f32 v194, v60, v61
  v_mfma_f32_16x16x32_bf16 v[92:95], v[148:151], v[164:167], v[92:95]
  v_cvt_pk_bf16_f32 v195, v62, v63
  buffer_store_dwordx4 v[192:195], v184, s[52:55], s75 offen offset:256 sc1
  s_add_u32 s75, s75, 266240
  v_cvt_pk_bf16_f32 v196, v64, v65
  v_cvt_pk_bf16_f32 v197, v66, v67
  v_cvt_pk_bf16_f32 v198, v68, v69
  v_cvt_pk_bf16_f32 v199, v70, v71
  buffer_store_dwordx4 v[196:199], v184, s[52:55], s75 offen offset:0 sc1
  v_cvt_pk_bf16_f32 v200, v72, v73
  v_cvt_pk_bf16_f32 v201, v74, v75
  v_cvt_pk_bf16_f32 v202, v76, v77
  v_cvt_pk_bf16_f32 v203, v78, v79
  buffer_store_dwordx4 v[200:203], v184, s[52:55], s75 offen offset:256 sc1
  s_add_u32 s75, s75, 266240
  v_cvt_pk_bf16_f32 v188, v80, v81
  v_cvt_pk_bf16_f32 v189, v82, v83
  v_cvt_pk_bf16_f32 v190, v84, v85
  v_cvt_pk_bf16_f32 v191, v86, v87
  buffer_store_dwordx4 v[188:191], v184, s[52:55], s75 offen offset:0 sc1
  v_cvt_pk_bf16_f32 v192, v88, v89
  v_cvt_pk_bf16_f32 v193, v90, v91
  v_cvt_pk_bf16_f32 v194, v92, v93
  v_cvt_pk_bf16_f32 v195, v94, v95
  buffer_store_dwordx4 v[192:195], v184, s[52:55], s75 offen offset:256 sc1
  s_branch k_ef
k_eg:
  v_mfma_f32_16x16x32_bf16 v[16:19], v[132:135], v[152:155], v[16:19]
  v_mfma_f32_16x16x32_bf16 v[20:23], v[132:135], v[156:159], v[20:23]
  v_mfma_f32_16x16x32_bf16 v[24:27], v[132:135], v[160:163], v[24:27]
  v_mfma_f32_16x16x32_bf16 v[28:31], v[132:135], v[164:167], v[28:31]
  v_mfma_f32_16x16x32_bf16 v[32:35], v[136:139], v[152:155], v[32:35]
  v_mfma_f32_16x16x32_bf16 v[48:51], v[140:143], v[152:155], v[48:51]
  v_mfma_f32_16x16x32_bf16 v[64:67], v[144:147], v[152:155], v[64:67]
  v_mfma_f32_16x16x32_bf16 v[80:83], v[148:151], v[152:155], v[80:83]
  v_mfma_f32_16x16x32_bf16 v[36:39], v[136:139], v[156:159], v[36:39]
  v_mul_f32 v16, s76, v16
  v_mul_f32 v17, s76, v17
  v_mul_f32 v18, s76, v18
  v_mul_f32 v19, s76, v19
  v_mfma_f32_16x16x32_bf16 v[52:55], v[140:143], v[156:159], v[52:55]
  v_cvt_pk_bf16_f32 v188, v16, v17
  v_cvt_pk_bf16_f32 v189, v18, v19
  v_mul_f32 v20, s76, v20
  v_mfma_f32_16x16x32_bf16 v[68:71], v[144:147], v[156:159], v[68:71]
  v_mul_f32 v21, s76, v21
  v_mul_f32 v22, s76, v22
  v_mul_f32 v23, s76, v23
  v_mfma_f32_16x16x32_bf16 v[84:87], v[148:151], v[156:159], v[84:87]
  v_cvt_pk_bf16_f32 v190, v20, v21
  v_cvt_pk_bf16_f32 v191, v22, v23
  buffer_store_dwordx4 v[188:191], v184, s[52:55], s75 offen offset:0 sc1
  v_mfma_f32_16x16x32_bf16 v[40:43], v[136:139], v[160:163], v[40:43]
  v_mul_f32 v24, s76, v24
  v_mul_f32 v25, s76, v25
  v_mul_f32 v26, s76, v26
  v_mul_f32 v27, s76, v27
  v_mfma_f32_16x16x32_bf16 v[56:59], v[140:143], v[160:163], v[56:59]
  v_cvt_pk_bf16_f32 v192, v24, v25
  v_cvt_pk_bf16_f32 v193, v26, v27
  v_mul_f32 v28, s76, v28
  v_mfma_f32_16x16x32_bf16 v[72:75], v[144:147], v[160:163], v[72:75]
  v_mul_f32 v29, s76, v29
  v_mul_f32 v30, s76, v30
  v_mul_f32 v31, s76, v31
  v_mfma_f32_16x16x32_bf16 v[88:91], v[148:151], v[160:163], v[88:91]
  v_cvt_pk_bf16_f32 v194, v28, v29
  v_cvt_pk_bf16_f32 v195, v30, v31
  buffer_store_dwordx4 v[192:195], v184, s[52:55], s75 offen offset:256 sc1
  v_mfma_f32_16x16x32_bf16 v[44:47], v[136:139], v[164:167], v[44:47]
  v_mfma_f32_16x16x32_bf16 v[60:63], v[140:143], v[164:167], v[60:63]
  v_mfma_f32_16x16x32_bf16 v[76:79], v[144:147], v[164:167], v[76:79]
  v_mfma_f32_16x16x32_bf16 v[92:95], v[148:151], v[164:167], v[92:95]
  s_mov_b32 s76, 0xbfb8aa3b
  s_lshl_b32 s46, s70, 1
  s_add_u32 s46, s46, s27
  s_mul_i32 s46, s46, 272
  s_lshl_b32 s75, s71, 2
  s_add_u32 s46, s46, s75
  s_add_u32 s46, s46, s73
  s_lshl_b32 s46, s46, 10
  s_add_u32 s46, s46, 8388608
  v_mul_f32 v104, s76, v32
  v_mul_f32 v105, s76, v33
  v_mul_f32 v106, s76, v34
  v_mul_f32 v107, s76, v35
  v_mul_f32 v108, s76, v48
  v_mul_f32 v109, s76, v49
  v_mul_f32 v110, s76, v50
  v_mul_f32 v111, s76, v51
  v_exp_f32 v104, v104
  v_exp_f32 v105, v105
  v_exp_f32 v106, v106
  v_exp_f32 v107, v107
  v_exp_f32 v108, v108
  v_exp_f32 v109, v109
  v_exp_f32 v110, v110
  v_exp_f32 v111, v111
  v_mul_f32 v32, v32, v64
  v_add_f32 v104, 1.0, v104
  v_mul_f32 v33, v33, v65
  v_add_f32 v105, 1.0, v105
  v_mul_f32 v34, v34, v66
  v_add_f32 v106, 1.0, v106
  v_mul_f32 v35, v35, v67
  v_add_f32 v107, 1.0, v107
  v_mul_f32 v48, v48, v80
  v_add_f32 v108, 1.0, v108
  v_mul_f32 v49, v49, v81
  v_add_f32 v109, 1.0, v109
  v_mul_f32 v50, v50, v82
  v_add_f32 v110, 1.0, v110
  v_mul_f32 v51, v51, v83
  v_add_f32 v111, 1.0, v111
  v_rcp_f32 v104, v104
  v_rcp_f32 v105, v105
  v_rcp_f32 v106, v106
  v_rcp_f32 v107, v107
  v_rcp_f32 v108, v108
  v_rcp_f32 v109, v109
  v_rcp_f32 v110, v110
  v_rcp_f32 v111, v111
  s_nop 0
  v_mul_f32 v104, v104, v32
  v_mul_f32 v105, v105, v33
  v_mul_f32 v106, v106, v34
  v_mul_f32 v107, v107, v35
  v_mul_f32 v108, v108, v48
  v_mul_f32 v109, v109, v49
  v_mul_f32 v110, v110, v50
  v_mul_f32 v111, v111, v51
  v_cvt_pk_bf16_f32 v210, v104, v105
  v_cvt_pk_bf16_f32 v211, v106, v107
  v_cvt_pk_bf16_f32 v212, v108, v109
  v_cvt_pk_bf16_f32 v213, v110, v111
k_ef:
  s_and_b32 s60, s2, 31
  s_lshr_b32 s61, s2, 5
  s_mov_b32 s99, 22085632
  s_waitcnt vmcnt(0)
  s_barrier
  s_cmp_eq_u32 s26, 0
  s_cbranch_scc0 k_f1
  s_mov_b64 exec, 4
  buffer_store_dword v246, v245, s[52:55], 0 offen sc1
  s_mov_b64 exec, -1
k_f1:
  s_mul_i32 s50, s45, 163840
  s_add_u32 s50, s50, s40
  s_and_b32 s51, s45, 7
  s_mul_i32 s51, s51, 20480
  s_add_u32 s51, s51, s41
  s_and_b32 s62, s26, 3
  s_lshr_b32 s63, s26, 2
  s_lshl_b32 s5, s61, 1
  s_add_u32 s5, s5, s62
  s_sub_u32 s5, s5, 2
  s_cselect_b32 s5, s62, s5
  s_lshl_b32 s5, s5, 10
  s_add_u32 s65, s60, 32
  s_mul_i32 s65, s65, 5
  s_mul_i32 s64, s63, 3
  s_add_u32 s65, s65, s64
  s_mul_i32 s65, s65, 16640
  s_add_u32 s5, s5, s65
  s_mul_i32 s64, s64, 4128
  s_lshl_b32 s62, s62, 10
  s_add_u32 s4, s62, s64
  s_mul_i32 s10, s63, 2612480
  s_mul_i32 s11, s63, 12384
  v_lshlrev_b32 v98, 4, v0
  v_and_b32 v99, 31, v0
  v_lshrrev_b32 v100, 5, v0
  v_lshlrev_b32 v101, 3, v99
  v_mul_u32_u24 v100, 33280, v100
  v_add_u32 v100, v100, v101
  v_lshrrev_b32 v99, 3, v99
  v_lshlrev_b32 v99, 5, v99
  v_and_or_b32 v99, v0, 7, v99
  v_lshlrev_b32 v99, 2, v99
  s_lshl_b32 s62, s61, 3
  s_add_u32 s62, s62, s26
  s_lshl_b32 s63, s62, 8
  s_mul_i32 s64, s60, 83200
  s_add_u32 s6, s63, s64
  s_add_u32 s7, s6, 16640
  s_add_u32 s8, s6, 66560
  s_lshl_b32 s62, s62, 9
  s_add_u32 s9, s62, 22020096
  s_cmp_lt_u32 s47, 12
  s_cbranch_scc0 k_nh0
  buffer_store_dwordx4 v[210:213], v244, s[52:55], s46 offen sc1
  s_add_u32 s46, s46, 69632
  v_mul_f32 v104, s76, v36
  v_mul_f32 v105, s76, v37
  v_mul_f32 v106, s76, v38
  v_mul_f32 v107, s76, v39
  v_mul_f32 v108, s76, v52
  v_mul_f32 v109, s76, v53
  v_mul_f32 v110, s76, v54
  v_mul_f32 v111, s76, v55
  v_exp_f32 v104, v104
  v_exp_f32 v105, v105
  v_exp_f32 v106, v106
  v_exp_f32 v107, v107
  v_exp_f32 v108, v108
  v_exp_f32 v109, v109
  v_exp_f32 v110, v110
  v_exp_f32 v111, v111
  v_mul_f32 v36, v36, v68
  v_add_f32 v104, 1.0, v104
  v_mul_f32 v37, v37, v69
  v_add_f32 v105, 1.0, v105
  v_mul_f32 v38, v38, v70
  v_add_f32 v106, 1.0, v106
  v_mul_f32 v39, v39, v71
  v_add_f32 v107, 1.0, v107
  v_mul_f32 v52, v52, v84
  v_add_f32 v108, 1.0, v108
  v_mul_f32 v53, v53, v85
  v_add_f32 v109, 1.0, v109
  v_mul_f32 v54, v54, v86
  v_add_f32 v110, 1.0, v110
  v_mul_f32 v55, v55, v87
  v_add_f32 v111, 1.0, v111
  v_rcp_f32 v104, v104
  v_rcp_f32 v105, v105
  v_rcp_f32 v106, v106
  v_rcp_f32 v107, v107
  v_rcp_f32 v108, v108
  v_rcp_f32 v109, v109
  v_rcp_f32 v110, v110
  v_rcp_f32 v111, v111
  s_nop 0
  v_mul_f32 v104, v104, v36
  v_mul_f32 v105, v105, v37
  v_mul_f32 v106, v106, v38
  v_mul_f32 v107, v107, v39
  v_mul_f32 v108, v108, v52
  v_mul_f32 v109, v109, v53
  v_mul_f32 v110, v110, v54
  v_mul_f32 v111, v111, v55
  v_cvt_pk_bf16_f32 v214, v104, v105
  v_cvt_pk_bf16_f32 v215, v106, v107
  v_cvt_pk_bf16_f32 v216, v108, v109
  v_cvt_pk_bf16_f32 v217, v110, v111
  buffer_store_dwordx4 v[214:217], v244, s[52:55], s46 offen sc1
  s_add_u32 s46, s46, 69632
  v_mul_f32 v104, s76, v40
  v_mul_f32 v105, s76, v41
  v_mul_f32 v106, s76, v42
  v_mul_f32 v107, s76, v43
  v_mul_f32 v108, s76, v56
  v_mul_f32 v109, s76, v57
  v_mul_f32 v110, s76, v58
  v_mul_f32 v111, s76, v59
  v_exp_f32 v104, v104
  v_exp_f32 v105, v105
  v_exp_f32 v106, v106
  v_exp_f32 v107, v107
  v_exp_f32 v108, v108
  v_exp_f32 v109, v109
  v_exp_f32 v110, v110
  v_exp_f32 v111, v111
  v_mul_f32 v40, v40, v72
  v_add_f32 v104, 1.0, v104
  v_mul_f32 v41, v41, v73
  v_add_f32 v105, 1.0, v105
  v_mul_f32 v42, v42, v74
  v_add_f32 v106, 1.0, v106
  v_mul_f32 v43, v43, v75
  v_add_f32 v107, 1.0, v107
  v_mul_f32 v56, v56, v88
  v_add_f32 v108, 1.0, v108
  v_mul_f32 v57, v57, v89
  v_add_f32 v109, 1.0, v109
  v_mul_f32 v58, v58, v90
  v_add_f32 v110, 1.0, v110
  v_mul_f32 v59, v59, v91
  v_add_f32 v111, 1.0, v111
  v_rcp_f32 v104, v104
  v_rcp_f32 v105, v105
  v_rcp_f32 v106, v106
  v_rcp_f32 v107, v107
  v_rcp_f32 v108, v108
  v_rcp_f32 v109, v109
  v_rcp_f32 v110, v110
  v_rcp_f32 v111, v111
  s_nop 0
  v_mul_f32 v104, v104, v40
  v_mul_f32 v105, v105, v41
  v_mul_f32 v106, v106, v42
  v_mul_f32 v107, v107, v43
  v_mul_f32 v108, v108, v56
  v_mul_f32 v109, v109, v57
  v_mul_f32 v110, v110, v58
  v_mul_f32 v111, v111, v59
  v_cvt_pk_bf16_f32 v218, v104, v105
  v_cvt_pk_bf16_f32 v219, v106, v107
  v_cvt_pk_bf16_f32 v220, v108, v109
  v_cvt_pk_bf16_f32 v221, v110, v111
  buffer_store_dwordx4 v[218:221], v244, s[52:55], s46 offen sc1
  s_add_u32 s46, s46, 69632
  v_mul_f32 v104, s76, v44
  v_mul_f32 v105, s76, v45
  v_mul_f32 v106, s76, v46
  v_mul_f32 v107, s76, v47
  v_mul_f32 v108, s76, v60
  v_mul_f32 v109, s76, v61
  v_mul_f32 v110, s76, v62
  v_mul_f32 v111, s76, v63
  v_exp_f32 v104, v104
  v_exp_f32 v105, v105
  v_exp_f32 v106, v106
  v_exp_f32 v107, v107
  v_exp_f32 v108, v108
  v_exp_f32 v109, v109
  v_exp_f32 v110, v110
  v_exp_f32 v111, v111
  v_mul_f32 v44, v44, v76
  v_add_f32 v104, 1.0, v104
  v_mul_f32 v45, v45, v77
  v_add_f32 v105, 1.0, v105
  v_mul_f32 v46, v46, v78
  v_add_f32 v106, 1.0, v106
  v_mul_f32 v47, v47, v79
  v_add_f32 v107, 1.0, v107
  v_mul_f32 v60, v60, v92
  v_add_f32 v108, 1.0, v108
  v_mul_f32 v61, v61, v93
  v_add_f32 v109, 1.0, v109
  v_mul_f32 v62, v62, v94
  v_add_f32 v110, 1.0, v110
  v_mul_f32 v63, v63, v95
  v_add_f32 v111, 1.0, v111
  v_rcp_f32 v104, v104
  v_rcp_f32 v105, v105
  v_rcp_f32 v106, v106
  v_rcp_f32 v107, v107
  v_rcp_f32 v108, v108
  v_rcp_f32 v109, v109
  v_rcp_f32 v110, v110
  v_rcp_f32 v111, v111
  s_nop 0
  v_mul_f32 v104, v104, v44
  v_mul_f32 v105, v105, v45
  v_mul_f32 v106, v106, v46
  v_mul_f32 v107, v107, v47
  v_mul_f32 v108, v108, v60
  v_mul_f32 v109, v109, v61
  v_mul_f32 v110, v110, v62
  v_mul_f32 v111, v111, v63
  v_cvt_pk_bf16_f32 v222, v104, v105
  v_cvt_pk_bf16_f32 v223, v106, v107
  v_cvt_pk_bf16_f32 v224, v108, v109
  v_cvt_pk_bf16_f32 v225, v110, v111
  buffer_store_dwordx4 v[222:225], v244, s[52:55], s46 offen sc1
  s_add_u32 s46, s46, 69632
k_nh0:
  s_and_b32 s62, s26, 3
  s_lshl_b32 s63, s61, 1
  s_add_u32 s64, s63, s62
  s_sub_u32 s64, s64, 2
  s_cselect_b32 s64, s62, s64
  s_lshl_b32 s64, s64, 4
  s_lshr_b32 s62, s60, 4
  s_add_u32 s64, s64, s62
  s_add_u32 s64, s64, 12
  v_mov_b32 v130, s64
  s_add_u32 s64, s64, 2
  v_writelane_b32 v130, s64, 1
  s_add_u32 s63, s63, s27
  s_lshl_b32 s63, s63, 4
  s_mul_i32 s62, s60, 20
  s_lshr_b32 s64, s62, 6
  s_min_u32 s65, s64, 1
  s_add_u32 s65, s65, s64
  s_lshr_b32 s64, s64, 3
  s_add_u32 s65, s65, s64
  s_add_u32 s65, s65, s63
  v_writelane_b32 v130, s65, 2
  s_add_u32 s62, s62, 19
  s_lshr_b32 s64, s62, 6
  s_min_u32 s65, s64, 1
  s_add_u32 s65, s65, s64
  s_lshr_b32 s64, s64, 3
  s_add_u32 s65, s65, s64
  s_add_u32 s65, s65, s63
  v_writelane_b32 v130, s65, 3
  s_add_u32 s62, s62, 19
  v_lshlrev_b32 v130, 7, v130
  buffer_load_dword v247, v130, s[52:55], s99 offen sc1
  s_lshl_b32 s62, s26, 9
  s_add_u32 s62, s62, 102400
  v_lshl_add_u32 v82, v0, 3, s62
  s_lshr_b32 s63, s26, 2
  s_or_b32 s63, s63, s61
  s_cmp_eq_u32 s63, 0
  s_cselect_b32 s63, 0xf149, 0
  v_mov_b32 v84, s63
  v_mov_b32 v85, 0
  v_mov_b32 v86, 0x3f803f80
  v_mov_b32 v87, 0x3f803f80
  ds_write_b64 v82, v[84:85] offset:20640
  ds_write_b64 v82, v[86:87] offset:45408
  v_and_b32 v82, 31, v0
  v_lshrrev_b32 v83, 5, v0
  s_lshl_b32 s62, s26, 8
  s_add_u32 s62, s62, 102400
  v_lshl_add_u32 v84, v82, 3, s62
  v_mul_u32_u24 v85, 4128, v83
  v_add_u32 v3, v84, v85
  v_add_u32 v2, v3, v85
  v_and_b32 v85, 3, v0
  v_min_u32 v86, 1, v85
  v_add_u32 v86, 4, v86
  v_and_b32 v87, 16, v0
  v_cmp_eq_u32 vcc, 0, v87
  v_bfe_u32 v87, v0, 2, 2
  v_lshl_add_u32 v87, v83, 2, v87
  v_cndmask_b32 v85, v86, v85, vcc
  v_mul_u32_u24 v85, 4128, v85
  v_lshl_add_u32 v85, v87, 3, v85
  v_add_u32 v12, s62, v85
  s_mov_b32 s66, 0xffffffff
  s_mov_b32 s67, 0xfffffff0
  s_mov_b32 s68, 0xfffffffe
  s_mov_b32 s69, 0xffffffe0
  s_mov_b32 s70, 0xfffffffc
  s_mov_b32 s71, 0xffffffc0
  s_mov_b32 s72, 0xfffffff8
  s_mov_b32 s73, 0xffffff80
  s_mov_b32 s74, 0xffffff00
  s_mov_b32 s75, 0xfffff000
  s_mov_b32 s76, 0xfffffe00
  s_mov_b32 s77, 0xffffe000
  s_mov_b32 s78, 0xfffffc00
  s_mov_b32 s79, 0xffffc000
  s_mov_b32 s80, 0xfffff800
  s_mov_b32 s81, 0xffff8000
  s_mov_b32 s82, 0xffff0000
  s_mov_b32 s83, 0xfff00000
  s_mov_b32 s84, 0xfffe0000
  s_mov_b32 s85, 0xffe00000
  s_mov_b32 s86, 0xfffc0000
  s_mov_b32 s87, 0xffc00000
  s_mov_b32 s88, 0xfff80000
  s_mov_b32 s89, 0xff800000
  s_mov_b32 s90, 0xff000000
  s_mov_b32 s91, 0xf0000000
  s_mov_b32 s92, 0xfe000000
  s_mov_b32 s93, 0xe0000000
  s_mov_b32 s94, 0xfc000000
  s_mov_b32 s95, 0xc0000000
  s_mov_b32 s96, 0xf8000000
  s_mov_b32 s97, 0x80000000
  v_mov_b32 v86, 0xffff
  v_cndmask_b32 v14, 0, v86, s[66:67]
  v_cndmask_b32 v14, v14, -1, s[68:69]
  v_cndmask_b32 v15, 0, v86, s[70:71]
  v_cndmask_b32 v15, v15, -1, s[72:73]
  v_cndmask_b32 v16, 0, v86, s[74:75]
  v_cndmask_b32 v16, v16, -1, s[76:77]
  v_cndmask_b32 v17, 0, v86, s[78:79]
  v_cndmask_b32 v17, v17, -1, s[80:81]
  v_cndmask_b32 v18, 0, v86, s[82:83]
  v_cndmask_b32 v18, v18, -1, s[84:85]
  v_cndmask_b32 v19, 0, v86, s[86:87]
  v_cndmask_b32 v19, v19, -1, s[88:89]
  v_cndmask_b32 v20, 0, v86, s[90:91]
  v_cndmask_b32 v20, v20, -1, s[92:93]
  v_cndmask_b32 v21, 0, v86, s[94:95]
  v_cndmask_b32 v21, v21, -1, s[96:97]
  s_lshl_b32 s62, s61, 3
  s_add_u32 s62, s62, s26
  s_lshl_b32 s62, s62, 8
  s_mul_i32 s63, s60, 83200
  s_add_u32 s62, s62, s63
  s_add_u32 s62, s62, 24117248
  v_lshl_add_u32 v84, v82, 3, s62
  v_mul_u32_u24 v22, 16640, v83
  v_add_u32 v22, v22, v84
  v_add_u32 v23, 33280, v22
  v_lshl_add_u32 v24, v83, 30, v84
  v_add_u32 v24, 66560, v24
  v_mov_b32 v80, 0
  v_mov_b32 v81, 0
  v_mov_b32 v10, 0
  v_mov_b32 v11, 0
  s_waitcnt vmcnt(0)
  s_barrier
  s_cmp_eq_u32 s26, 2
  s_cbranch_scc0 k_f2
  s_mov_b64 exec, 1
  buffer_store_dword v246, v245, s[52:55], 0 offen sc1
  s_mov_b64 exec, -1
k_f2:
  s_mov_b32 s98, 0
  s_branch spin2c
spin2:
  buffer_load_dword v247, v130, s[52:55], s99 offen sc1
  s_waitcnt vmcnt(0)
spin2c:
  v_cmp_ne_u32 vcc, 1, v247
  s_add_u32 s98, s98, 1
  s_cbranch_vccz spin2d
  s_cmp_lt_u32 s98, 0x40000
  s_cbranch_scc1 spin2
spin2d:
  s_add_u32 m0, s4, 102400
  s_add_u32 s62, s5, 0
  buffer_load_dwordx4 v98, s[52:55], s62 offen sc1 lds
  s_add_u32 m0, s4, 106528
  s_add_u32 s62, s5, 16640
  buffer_load_dwordx4 v98, s[52:55], s62 offen sc1 lds
  s_add_u32 m0, s4, 110656
  s_add_u32 s62, s5, 33280
  s_add_u32 m0, m0, s11
  s_add_u32 s62, s62, s10
  buffer_load_dwordx4 v98, s[52:55], s62 offen sc1 lds
  buffer_load_dwordx2 v[4:5], v100, s[52:55], s6 offen sc1
  buffer_load_dwordx2 v[6:7], v100, s[52:55], s7 offen sc1
  buffer_load_dwordx2 v[8:9], v101, s[52:55], s8 offen sc1
  buffer_load_dword v1, v99, s[52:55], s9 offen sc1
  s_add_u32 m0, s4, 127168
  s_add_u32 s62, s5, 2662400
  buffer_load_dwordx4 v98, s[52:55], s62 offen sc1 lds
  s_add_u32 m0, s4, 131296
  s_add_u32 s62, s5, 2679040
  buffer_load_dwordx4 v98, s[52:55], s62 offen sc1 lds
  s_lshr_b32 s99, s32, 1
  s_lshl_b32 s99, s99, 9
  s_add_u32 s99, s99, 22118400
  v_and_b32 v248, 15, v0
  v_lshlrev_b32 v248, 5, v248
  s_waitcnt vmcnt(0) lgkmcnt(0)
  s_barrier
  s_cmp_eq_u32 s27, 0
  s_cbranch_scc1 k_pr0
  s_setprio 1
k_pr0:
  buffer_load_dword v247, v248, s[52:55], s99 offen sc1
  ds_read_b64 v[26:27], v2 offset:0
  ds_read_b64 v[28:29], v2 offset:4128
  ds_read_b64 v[30:31], v3 offset:16512
  ds_read_b64 v[32:33], v2 offset:256
  ds_read_b64 v[34:35], v2 offset:4384
  ds_read_b64 v[36:37], v3 offset:16768
  ds_read_b64 v[74:75], v2 offset:2048
  ds_read_b64 v[76:77], v2 offset:6176
  ds_read_b64 v[78:79], v3 offset:18560
  ds_read_b64 v[38:39], v2 offset:512
  ds_read_b64 v[40:41], v2 offset:4640
  ds_read_b64 v[42:43], v3 offset:17024
  ds_read_b64 v[44:45], v2 offset:768
  ds_read_b64 v[46:47], v2 offset:4896
  ds_read_b64 v[48:49], v3 offset:17280
  s_mov_b32 exec_lo, 0
  v_mov_b32 v8, 0x3f80
  v_mov_b32 v9, 0
  s_mov_b32 exec_lo, -1
  s_waitcnt lgkmcnt(6)
  v_mfma_f32_32x32x16_bf16 v[82:97], v[26:29], v[4:7], 0
  v_mfma_f32_32x32x16_bf16 v[82:97], v[30:33], v[8:11], v[82:97]
  v_mfma_f32_32x32x16_bf16 v[98:113], v[74:77], v[4:7], 0
  v_mfma_f32_32x32x16_bf16 v[98:113], v[78:81], v[8:11], v[98:113]
  s_waitcnt lgkmcnt(0)
  ds_read_b64 v[50:51], v2 offset:1024
  ds_read_b64 v[52:53], v2 offset:5152
  ds_read_b64 v[54:55], v3 offset:17536
  ds_read_b64 v[56:57], v2 offset:1280
  ds_read_b64 v[58:59], v2 offset:5408
  ds_read_b64 v[60:61], v3 offset:17792
  ds_read_b64 v[62:63], v2 offset:1536
  ds_read_b64 v[64:65], v2 offset:5664
  ds_read_b64 v[66:67], v3 offset:18048
  ds_read_b64 v[68:69], v2 offset:1792
  ds_read_b64 v[70:71], v2 offset:5920
  ds_read_b64 v[72:73], v3 offset:18304
  v_mfma_f32_32x32x16_bf16 v[114:129], v[32:35], v[4:7], 0
  v_mfma_f32_32x32x16_bf16 v[114:129], v[36:39], v[8:11], v[114:129]
  v_cndmask_b32 v130, v82, v98, s[66:67]
  v_cndmask_b32 v131, v83, v99, s[68:69]
  v_cndmask_b32 v132, v84, v100, s[70:71]
  v_cndmask_b32 v133, v85, v101, s[72:73]
  v_cndmask_b32 v134, v86, v102, s[74:75]
  v_cndmask_b32 v135, v87, v103, s[76:77]
  v_cndmask_b32 v136, v88, v104, s[78:79]
  v_cndmask_b32 v137, v89, v105, s[80:81]
  v_cndmask_b32 v138, v90, v106, s[82:83]
  v_cndmask_b32 v139, v91, v107, s[84:85]
  v_cndmask_b32 v140, v92, v108, s[86:87]
  v_cndmask_b32 v141, v93, v109, s[88:89]
  v_cndmask_b32 v142, v94, v110, s[90:91]
  v_cndmask_b32 v143, v95, v111, s[92:93]
  v_cndmask_b32 v144, v96, v112, s[94:95]
  v_cndmask_b32 v145, v97, v113, s[96:97]
  s_waitcnt lgkmcnt(0)
  v_mfma_f32_32x32x16_bf16 v[82:97], v[38:41], v[4:7], 0
  v_max_f32 v13, v130, v131
  v_max3_f32 v13, v132, v133, v13
  v_max3_f32 v13, v134, v135, v13
  v_max3_f32 v13, v136, v137, v13
  v_mfma_f32_32x32x16_bf16 v[82:97], v[42:45], v[8:11], v[82:97]
  v_max3_f32 v13, v138, v139, v13
  v_max3_f32 v13, v140, v141, v13
  v_max3_f32 v13, v142, v143, v13
  v_max3_f32 v13, v144, v145, v13
  v_mfma_f32_32x32x16_bf16 v[98:113], v[44:47], v[4:7], 0
  v_max3_f32 v13, v114, v115, v13
  v_max3_f32 v13, v116, v117, v13
  v_max3_f32 v13, v118, v119, v13
  v_max3_f32 v13, v120, v121, v13
  v_mfma_f32_32x32x16_bf16 v[98:113], v[48:51], v[8:11], v[98:113]
  v_max3_f32 v13, v122, v123, v13
  v_max3_f32 v13, v124, v125, v13
  v_max3_f32 v13, v126, v127, v13
  v_max3_f32 v13, v128, v129, v13
  v_mfma_f32_32x32x16_bf16 v[114:129], v[50:53], v[4:7], 0
  v_max3_f32 v13, v82, v83, v13
  v_max3_f32 v13, v84, v85, v13
  v_max3_f32 v13, v86, v87, v13
  v_max3_f32 v13, v88, v89, v13
  v_mfma_f32_32x32x16_bf16 v[114:129], v[54:57], v[8:11], v[114:129]
  v_max3_f32 v13, v90, v91, v13
  v_max3_f32 v13, v92, v93, v13
  v_max3_f32 v13, v94, v95, v13
  v_max3_f32 v13, v96, v97, v13
  v_mfma_f32_32x32x16_bf16 v[82:97], v[56:59], v[4:7], 0
  v_max3_f32 v13, v98, v99, v13
  v_max3_f32 v13, v100, v101, v13
  v_max3_f32 v13, v102, v103, v13
  v_max3_f32 v13, v104, v105, v13
  v_mfma_f32_32x32x16_bf16 v[82:97], v[60:63], v[8:11], v[82:97]
  v_max3_f32 v13, v106, v107, v13
  v_max3_f32 v13, v108, v109, v13
  v_max3_f32 v13, v110, v111, v13
  v_max3_f32 v13, v112, v113, v13
  s_waitcnt vmcnt(0)
  s_mov_b32 s98, 0
  s_branch spin3c
spin3:
  buffer_load_dword v247, v248, s[52:55], s99 offen sc1
  s_waitcnt vmcnt(0)
spin3c:
  v_cmp_ne_u32 vcc, 1, v247
  s_add_u32 s98, s98, 1
  s_cbranch_vccz spin3d
  s_cmp_lt_u32 s98, 0x40000
  s_cbranch_scc1 spin3
spin3d:
  s_add_u32 s36, s38, 0
  buffer_load_dwordx4 v[210:213], v244, s[52:55], s36 offen sc1
  v_mfma_f32_32x32x16_bf16 v[98:113], v[62:65], v[4:7], 0
  v_max3_f32 v13, v114, v115, v13
  v_max3_f32 v13, v116, v117, v13
  v_max3_f32 v13, v118, v119, v13
  v_max3_f32 v13, v120, v121, v13
  v_mfma_f32_32x32x16_bf16 v[98:113], v[66:69], v[8:11], v[98:113]
  v_max3_f32 v13, v122, v123, v13
  v_max3_f32 v13, v124, v125, v13
  v_max3_f32 v13, v126, v127, v13
  v_max3_f32 v13, v128, v129, v13
  s_add_u32 s36, s38, 69632
  buffer_load_dwordx4 v[214:217], v244, s[52:55], s36 offen sc1
  v_mfma_f32_32x32x16_bf16 v[114:129], v[68:71], v[4:7], 0
  v_max3_f32 v13, v82, v83, v13
  v_max3_f32 v13, v84, v85, v13
  v_max3_f32 v13, v86, v87, v13
  v_max3_f32 v13, v88, v89, v13
  v_mfma_f32_32x32x16_bf16 v[114:129], v[72:75], v[8:11], v[114:129]
  v_max3_f32 v13, v90, v91, v13
  v_max3_f32 v13, v92, v93, v13
  v_max3_f32 v13, v94, v95, v13
  v_max3_f32 v13, v96, v97, v13
  s_add_u32 s36, s38, 4096
  buffer_load_dwordx4 v[218:221], v244, s[52:55], s36 offen sc1
  v_max3_f32 v13, v98, v99, v13
  v_max3_f32 v13, v100, v101, v13
  v_max3_f32 v13, v102, v103, v13
  v_max3_f32 v13, v104, v105, v13
  v_max3_f32 v13, v106, v107, v13
  v_max3_f32 v13, v108, v109, v13
  v_max3_f32 v13, v110, v111, v13
  v_max3_f32 v13, v112, v113, v13
  s_add_u32 s36, s38, 73728
  buffer_load_dwordx4 v[222:225], v244, s[52:55], s36 offen sc1
  s_nop 1
  v_max3_f32 v13, v114, v115, v13
  v_max3_f32 v13, v116, v117, v13
  v_max3_f32 v13, v118, v119, v13
  v_max3_f32 v13, v120, v121, v13
  v_max3_f32 v13, v122, v123, v13
  v_max3_f32 v13, v124, v125, v13
  v_max3_f32 v13, v126, v127, v13
  v_max3_f32 v13, v128, v129, v13
  ds_read_b64_tr_b16 v[178:179], v12 offset:24768
  ds_read_b64_tr_b16 v[180:181], v12 offset:24832
  ds_read_b64_tr_b16 v[182:183], v12 offset:24896
  ds_read_b64_tr_b16 v[184:185], v12 offset:24960
  ds_read_b64_tr_b16 v[186:187], v12 offset:26816
  ds_read_b64_tr_b16 v[188:189], v12 offset:26880
  ds_read_b64_tr_b16 v[190:191], v12 offset:26944
  ds_read_b64_tr_b16 v[192:193], v12 offset:27008
  v_mov_b32 v146, v13
  s_nop 1
  v_permlane32_swap_b32 v146, v13
  s_nop 1
  v_max_f32 v13, v13, v146
  v_sub_f32 v146, 0, v13
  v_sub_f32 v147, 0, v13
  v_sub_f32 v148, 0, v13
  v_sub_f32 v149, 0, v13
  v_sub_f32 v150, 0, v13
  v_sub_f32 v151, 0, v13
  v_sub_f32 v152, 0, v13
  v_sub_f32 v153, 0, v13
  v_sub_f32 v154, 0, v13
  v_sub_f32 v155, 0, v13
  v_sub_f32 v156, 0, v13
  v_sub_f32 v157, 0, v13
  v_sub_f32 v158, 0, v13
  v_sub_f32 v159, 0, v13
  v_sub_f32 v160, 0, v13
  v_sub_f32 v161, 0, v13
  v_sub_f32 v130, v130, v13
  v_sub_f32 v131, v131, v13
  v_mfma_f32_32x32x16_bf16 v[98:113], v[32:35], v[4:7], v[146:161]
  v_sub_f32 v132, v132, v13
  s_add_u32 s36, s38, 8192
  buffer_load_dwordx4 v[226:229], v244, s[52:55], s36 offen sc1
  v_sub_f32 v133, v133, v13
  v_sub_f32 v134, v134, v13
  v_sub_f32 v135, v135, v13
  v_sub_f32 v136, v136, v13
  v_sub_f32 v137, v137, v13
  v_sub_f32 v138, v138, v13
  v_sub_f32 v139, v139, v13
  v_sub_f32 v140, v140, v13
  v_sub_f32 v141, v141, v13
  v_sub_f32 v142, v142, v13
  v_sub_f32 v143, v143, v13
  v_sub_f32 v144, v144, v13
  v_mfma_f32_32x32x16_bf16 v[98:113], v[36:39], v[8:11], v[98:113]
  v_sub_f32 v145, v145, v13
  s_add_u32 s36, s38, 77824
  buffer_load_dwordx4 v[230:233], v244, s[52:55], s36 offen sc1
  v_exp_f32 v130, v130
  v_exp_f32 v131, v131
  v_exp_f32 v132, v132
  v_exp_f32 v133, v133
  v_exp_f32 v134, v134
  v_exp_f32 v135, v135
  v_exp_f32 v136, v136
  v_exp_f32 v137, v137
  v_exp_f32 v138, v138
  v_exp_f32 v139, v139
  v_exp_f32 v140, v140
  v_exp_f32 v141, v141
  v_exp_f32 v142, v142
  v_mfma_f32_32x32x16_bf16 v[114:129], v[38:41], v[4:7], v[146:161]
  s_add_u32 s36, s38, 12288
  buffer_load_dwordx4 v[234:237], v244, s[52:55], s36 offen sc1
  v_exp_f32 v143, v143
  v_exp_f32 v144, v144
  v_exp_f32 v145, v145
  v_cvt_pk_bf16_f32 v194, v130, v131
  v_cvt_pk_bf16_f32 v195, v132, v133
  v_cvt_pk_bf16_f32 v196, v134, v135
  v_cvt_pk_bf16_f32 v197, v136, v137
  v_cvt_pk_bf16_f32 v198, v138, v139
  v_cvt_pk_bf16_f32 v199, v140, v141
  v_cvt_pk_bf16_f32 v200, v142, v143
  v_cvt_pk_bf16_f32 v201, v144, v145
  v_and_b32 v202, v194, v14
  v_and_b32 v203, v195, v15
  v_mfma_f32_32x32x16_bf16 v[114:129], v[42:45], v[8:11], v[114:129]
  s_add_u32 s36, s38, 81920
  buffer_load_dwordx4 v[238:241], v244, s[52:55], s36 offen sc1
  v_and_b32 v204, v196, v16
  v_and_b32 v205, v197, v17
  v_and_b32 v206, v198, v18
  v_and_b32 v207, v199, v19
  v_and_b32 v208, v200, v20
  v_and_b32 v209, v201, v21
  v_xor_b32 v194, v194, v202
  v_xor_b32 v195, v195, v203
  v_xor_b32 v196, v196, v204
  v_xor_b32 v197, v197, v205
  v_xor_b32 v198, v198, v206
  v_xor_b32 v199, v199, v207
  v_xor_b32 v200, v200, v208
  v_xor_b32 v201, v201, v209
  v_exp_f32 v98, v98
  v_exp_f32 v99, v99
  s_waitcnt lgkmcnt(0)
  v_mfma_f32_32x32x16_bf16 v[162:177], v[178:181], v[194:197], 0
  v_exp_f32 v100, v100
  s_add_u32 s36, s38, 40960
  buffer_load_dwordx4 v[74:77], v244, s[52:55], s36 offen sc1
  v_exp_f32 v101, v101
  v_exp_f32 v102, v102
  v_mfma_f32_32x32x16_bf16 v[162:177], v[182:185], v[198:201], v[162:177]
  v_exp_f32 v103, v103
  v_exp_f32 v104, v104
  v_exp_f32 v105, v105
  s_add_u32 s36, s38, 110592
  buffer_load_dwordx4 v[78:81], v244, s[52:55], s36 offen sc1
  v_exp_f32 v106, v106
  v_mfma_f32_32x32x16_bf16 v[162:177], v[186:189], v[202:205], v[162:177]
  v_exp_f32 v107, v107
  v_exp_f32 v108, v108
  v_exp_f32 v109, v109
  v_mfma_f32_32x32x16_bf16 v[162:177], v[190:193], v[206:209], v[162:177]
  ds_read_b64_tr_b16 v[178:179], v12 offset:25024
  ds_read_b64_tr_b16 v[180:181], v12 offset:25088
  ds_read_b64_tr_b16 v[182:183], v12 offset:25152
  ds_read_b64_tr_b16 v[184:185], v12 offset:25216
  v_exp_f32 v110, v110
  s_add_u32 s36, s38, 16384
  buffer_load_dwordx4 v[26:29], v244, s[52:55], s36 offen sc1
  v_exp_f32 v111, v111
  v_exp_f32 v112, v112
  v_exp_f32 v113, v113
  v_mfma_f32_32x32x16_bf16 v[82:97], v[44:47], v[4:7], v[146:161]
  v_cvt_pk_bf16_f32 v194, v98, v99
  v_cvt_pk_bf16_f32 v195, v100, v101
  s_add_u32 s36, s38, 86016
  buffer_load_dwordx4 v[30:33], v244, s[52:55], s36 offen sc1
  v_cvt_pk_bf16_f32 v196, v102, v103
  v_cvt_pk_bf16_f32 v197, v104, v105
  v_mfma_f32_32x32x16_bf16 v[82:97], v[48:51], v[8:11], v[82:97]
  v_cvt_pk_bf16_f32 v198, v106, v107
  v_cvt_pk_bf16_f32 v199, v108, v109
  v_cvt_pk_bf16_f32 v200, v110, v111
  v_cvt_pk_bf16_f32 v201, v112, v113
  s_setprio 0
  v_exp_f32 v114, v114
  v_exp_f32 v115, v115
  s_waitcnt lgkmcnt(0)
  v_mfma_f32_32x32x16_bf16 v[162:177], v[178:181], v[194:197], v[162:177]
  v_exp_f32 v116, v116
  s_add_u32 s36, s38, 45056
  buffer_load_dwordx4 v[14:17], v244, s[52:55], s36 offen sc1
  v_exp_f32 v117, v117
  v_exp_f32 v118, v118
  v_exp_f32 v119, v119
  v_exp_f32 v120, v120
  v_mfma_f32_32x32x16_bf16 v[162:177], v[182:185], v[198:201], v[162:177]
  ds_read_b64_tr_b16 v[186:187], v12 offset:25280
  ds_read_b64_tr_b16 v[188:189], v12 offset:25344
  ds_read_b64_tr_b16 v[190:191], v12 offset:25408
  ds_read_b64_tr_b16 v[192:193], v12 offset:25472
  v_exp_f32 v121, v121
  v_exp_f32 v122, v122
  v_exp_f32 v123, v123
  v_exp_f32 v124, v124
  v_exp_f32 v125, v125
  v_exp_f32 v126, v126
  v_mfma_f32_32x32x16_bf16 v[98:113], v[50:53], v[4:7], v[146:161]
  s_add_u32 s36, s38, 114688
  buffer_load_dwordx4 v[18:21], v244, s[52:55], s36 offen sc1
  v_exp_f32 v127, v127
  v_exp_f32 v128, v128
  v_exp_f32 v129, v129
  v_cvt_pk_bf16_f32 v202, v114, v115
  v_cvt_pk_bf16_f32 v203, v116, v117
  v_mfma_f32_32x32x16_bf16 v[98:113], v[54:57], v[8:11], v[98:113]
  v_cvt_pk_bf16_f32 v204, v118, v119
  v_cvt_pk_bf16_f32 v205, v120, v121
  v_cvt_pk_bf16_f32 v206, v122, v123
  v_cvt_pk_bf16_f32 v207, v124, v125
  v_cvt_pk_bf16_f32 v208, v126, v127
  v_cvt_pk_bf16_f32 v209, v128, v129
  v_exp_f32 v82, v82
  v_exp_f32 v83, v83
  s_waitcnt lgkmcnt(0)
  v_mfma_f32_32x32x16_bf16 v[162:177], v[186:189], v[202:205], v[162:177]
  v_exp_f32 v84, v84
  s_add_u32 s36, s38, 20480
  buffer_load_dwordx4 v[34:37], v244, s[52:55], s36 offen sc1
  v_exp_f32 v85, v85
  v_exp_f32 v86, v86
  v_exp_f32 v87, v87
  v_exp_f32 v88, v88
  v_mfma_f32_32x32x16_bf16 v[162:177], v[190:193], v[206:209], v[162:177]
  ds_read_b64_tr_b16 v[178:179], v12 offset:25536
  ds_read_b64_tr_b16 v[180:181], v12 offset:25600
  ds_read_b64_tr_b16 v[182:183], v12 offset:25664
  ds_read_b64_tr_b16 v[184:185], v12 offset:25728
  v_exp_f32 v89, v89
  v_exp_f32 v90, v90
  v_exp_f32 v91, v91
  v_exp_f32 v92, v92
  v_exp_f32 v93, v93
  v_exp_f32 v94, v94
  v_mfma_f32_32x32x16_bf16 v[114:129], v[56:59], v[4:7], v[146:161]
  s_add_u32 s36, s38, 90112
  buffer_load_dwordx4 v[38:41], v244, s[52:55], s36 offen sc1
  v_exp_f32 v95, v95
  v_exp_f32 v96, v96
  v_exp_f32 v97, v97
  v_cvt_pk_bf16_f32 v194, v82, v83
  v_cvt_pk_bf16_f32 v195, v84, v85
  v_mfma_f32_32x32x16_bf16 v[114:129], v[60:63], v[8:11], v[114:129]
  v_cvt_pk_bf16_f32 v196, v86, v87
  v_cvt_pk_bf16_f32 v197, v88, v89
  v_cvt_pk_bf16_f32 v198, v90, v91
  v_cvt_pk_bf16_f32 v199, v92, v93
  v_cvt_pk_bf16_f32 v200, v94, v95
  v_cvt_pk_bf16_f32 v201, v96, v97
  v_exp_f32 v98, v98
  v_exp_f32 v99, v99
  s_waitcnt lgkmcnt(0)
  v_mfma_f32_32x32x16_bf16 v[162:177], v[178:181], v[194:197], v[162:177]
  v_exp_f32 v100, v100
  s_add_u32 s36, s38, 24576
  buffer_load_dwordx4 v[42:45], v244, s[52:55], s36 offen sc1
  v_exp_f32 v101, v101
  v_exp_f32 v102, v102
  v_exp_f32 v103, v103
  v_exp_f32 v104, v104
  v_mfma_f32_32x32x16_bf16 v[162:177], v[182:185], v[198:201], v[162:177]
  ds_read_b64_tr_b16 v[186:187], v12 offset:25792
  ds_read_b64_tr_b16 v[188:189], v12 offset:25856
  ds_read_b64_tr_b16 v[190:191], v12 offset:25920
  ds_read_b64_tr_b16 v[192:193], v12 offset:25984
  v_exp_f32 v105, v105
  v_exp_f32 v106, v106
  v_exp_f32 v107, v107
  v_exp_f32 v108, v108
  v_exp_f32 v109, v109
  v_exp_f32 v110, v110
  v_mfma_f32_32x32x16_bf16 v[82:97], v[62:65], v[4:7], v[146:161]
  s_add_u32 s36, s38, 94208
  buffer_load_dwordx4 v[46:49], v244, s[52:55], s36 offen sc1
  v_exp_f32 v111, v111
  v_exp_f32 v112, v112
  v_exp_f32 v113, v113
  v_cvt_pk_bf16_f32 v202, v98, v99
  v_cvt_pk_bf16_f32 v203, v100, v101
  v_mfma_f32_32x32x16_bf16 v[82:97], v[66:69], v[8:11], v[82:97]
  v_cvt_pk_bf16_f32 v204, v102, v103
  v_cvt_pk_bf16_f32 v205, v104, v105
  v_cvt_pk_bf16_f32 v206, v106, v107
  v_cvt_pk_bf16_f32 v207, v108, v109
  v_cvt_pk_bf16_f32 v208, v110, v111
  v_cvt_pk_bf16_f32 v209, v112, v113
  v_exp_f32 v114, v114
  v_exp_f32 v115, v115
  s_waitcnt lgkmcnt(0)
  v_mfma_f32_32x32x16_bf16 v[162:177], v[186:189], v[202:205], v[162:177]
  v_exp_f32 v116, v116
  s_add_u32 s36, s38, 28672
  buffer_load_dwordx4 v[50:53], v244, s[52:55], s36 offen sc1
  v_exp_f32 v117, v117
  v_exp_f32 v118, v118
  v_exp_f32 v119, v119
  v_exp_f32 v120, v120
  v_mfma_f32_32x32x16_bf16 v[162:177], v[190:193], v[206:209], v[162:177]
  ds_read_b64_tr_b16 v[178:179], v12 offset:26048
  ds_read_b64_tr_b16 v[180:181], v12 offset:26112
  ds_read_b64_tr_b16 v[182:183], v12 offset:26176
  ds_read_b64_tr_b16 v[184:185], v12 offset:26240
  v_exp_f32 v121, v121
  v_exp_f32 v122, v122
  v_exp_f32 v123, v123
  v_exp_f32 v124, v124
  v_exp_f32 v125, v125
  v_exp_f32 v126, v126
  v_mfma_f32_32x32x16_bf16 v[98:113], v[68:71], v[4:7], v[146:161]
  s_add_u32 s36, s38, 98304
  buffer_load_dwordx4 v[54:57], v244, s[52:55], s36 offen sc1
  v_exp_f32 v127, v127
  v_exp_f32 v128, v128
  v_exp_f32 v129, v129
  v_cvt_pk_bf16_f32 v194, v114, v115
  v_cvt_pk_bf16_f32 v195, v116, v117
  v_mfma_f32_32x32x16_bf16 v[98:113], v[72:75], v[8:11], v[98:113]
  v_cvt_pk_bf16_f32 v196, v118, v119
  v_cvt_pk_bf16_f32 v197, v120, v121
  v_cvt_pk_bf16_f32 v198, v122, v123
  v_cvt_pk_bf16_f32 v199, v124, v125
  v_cvt_pk_bf16_f32 v200, v126, v127
  v_cvt_pk_bf16_f32 v201, v128, v129
  v_exp_f32 v82, v82
  v_exp_f32 v83, v83
  s_waitcnt lgkmcnt(0)
  v_mfma_f32_32x32x16_bf16 v[162:177], v[178:181], v[194:197], v[162:177]
  v_exp_f32 v84, v84
  s_add_u32 s36, s38, 32768
  buffer_load_dwordx4 v[58:61], v244, s[52:55], s36 offen sc1
  v_exp_f32 v85, v85
  v_exp_f32 v86, v86
  v_exp_f32 v87, v87
  v_exp_f32 v88, v88
  v_exp_f32 v89, v89
  s_add_u32 s36, s38, 102400
  buffer_load_dwordx4 v[62:65], v244, s[52:55], s36 offen sc1
  v_exp_f32 v90, v90
  v_exp_f32 v91, v91
  v_exp_f32 v92, v92
  v_exp_f32 v93, v93
  v_exp_f32 v94, v94
  v_mfma_f32_32x32x16_bf16 v[162:177], v[182:185], v[198:201], v[162:177]
  ds_read_b64_tr_b16 v[186:187], v12 offset:26304
  ds_read_b64_tr_b16 v[188:189], v12 offset:26368
  ds_read_b64_tr_b16 v[190:191], v12 offset:26432
  ds_read_b64_tr_b16 v[192:193], v12 offset:26496
  s_add_u32 s36, s38, 36864
  buffer_load_dwordx4 v[66:69], v244, s[52:55], s36 offen sc1
  v_exp_f32 v95, v95
  v_exp_f32 v96, v96
  v_exp_f32 v97, v97
  v_cvt_pk_bf16_f32 v202, v82, v83
  v_cvt_pk_bf16_f32 v203, v84, v85
  s_add_u32 s36, s38, 106496
  buffer_load_dwordx4 v[70:73], v244, s[52:55], s36 offen sc1
  v_cvt_pk_bf16_f32 v204, v86, v87
  v_cvt_pk_bf16_f32 v205, v88, v89
  v_cvt_pk_bf16_f32 v206, v90, v91
  v_cvt_pk_bf16_f32 v207, v92, v93
  v_cvt_pk_bf16_f32 v208, v94, v95
  v_cvt_pk_bf16_f32 v209, v96, v97
  v_exp_f32 v98, v98
  v_exp_f32 v99, v99
  s_waitcnt lgkmcnt(0)
  v_mfma_f32_32x32x16_bf16 v[162:177], v[186:189], v[202:205], v[162:177]
  v_exp_f32 v100, v100
  v_exp_f32 v101, v101
  v_exp_f32 v102, v102
  v_exp_f32 v103, v103
  v_exp_f32 v104, v104
  v_exp_f32 v105, v105
  v_exp_f32 v106, v106
  v_exp_f32 v107, v107
  v_exp_f32 v108, v108
  v_exp_f32 v109, v109
  v_exp_f32 v110, v110
  v_mfma_f32_32x32x16_bf16 v[162:177], v[190:193], v[206:209], v[162:177]
  ds_read_b64_tr_b16 v[178:179], v12 offset:26560
  ds_read_b64_tr_b16 v[180:181], v12 offset:26624
  ds_read_b64_tr_b16 v[182:183], v12 offset:26688
  ds_read_b64_tr_b16 v[184:185], v12 offset:26752
  v_exp_f32 v111, v111
  v_exp_f32 v112, v112
  v_exp_f32 v113, v113
  v_cvt_pk_bf16_f32 v194, v98, v99
  v_cvt_pk_bf16_f32 v195, v100, v101
  v_cvt_pk_bf16_f32 v196, v102, v103
  v_cvt_pk_bf16_f32 v197, v104, v105
  v_cvt_pk_bf16_f32 v198, v106, v107
  v_cvt_pk_bf16_f32 v199, v108, v109
  v_cvt_pk_bf16_f32 v200, v110, v111
  v_cvt_pk_bf16_f32 v201, v112, v113
  s_waitcnt lgkmcnt(0)
  s_nop 0
  v_mfma_f32_32x32x16_bf16 v[162:177], v[178:181], v[194:197], v[162:177]
  v_mfma_f32_32x32x16_bf16 v[162:177], v[182:185], v[198:201], v[162:177]
  s_nop 11
  v_rcp_f32 v13, v174
  s_nop 0
  v_mul_f32 v13, v13, v1
  v_mul_f32 v162, v162, v13
  v_mul_f32 v163, v163, v13
  v_mul_f32 v164, v164, v13
  v_mul_f32 v165, v165, v13
  v_mul_f32 v166, v166, v13
  v_mul_f32 v167, v167, v13
  v_mul_f32 v168, v168, v13
  v_mul_f32 v169, v169, v13
  v_mul_f32 v170, v170, v13
  v_mul_f32 v171, v171, v13
  v_mul_f32 v172, v172, v13
  v_mul_f32 v173, v173, v13
  v_cvt_pk_bf16_f32 v194, v162, v163
  v_cvt_pk_bf16_f32 v195, v164, v165
  v_cvt_pk_bf16_f32 v196, v166, v167
  v_cvt_pk_bf16_f32 v197, v168, v169
  v_cvt_pk_bf16_f32 v198, v170, v171
  v_cvt_pk_bf16_f32 v199, v172, v173
  buffer_store_dwordx2 v[194:195], v22, s[52:55], 0 offen sc1
  buffer_store_dwordx2 v[196:197], v23, s[52:55], 0 offen sc1
  buffer_store_dwordx2 v[198:199], v24, s[52:55], 0 offen sc1
  s_mov_b32 s28, s20
  s_mov_b32 s29, s21
  s_mov_b32 s30, 2621440
  s_mov_b32 s31, 0x20000
  v_and_b32 v2, 15, v0
  v_lshrrev_b32 v3, 4, v0
  v_mul_u32_u24 v3, 16640, v3
  v_lshl_add_u32 v4, v2, 4, v3
  v_lshrrev_b32 v2, 4, v0
  v_lshlrev_b32 v2, 7, v2
  v_bfe_u32 v3, v0, 3, 2
  v_lshlrev_b32 v3, 5, v3
  v_and_or_b32 v3, v0, 7, v3
  v_lshlrev_b32 v3, 2, v3
  s_lshr_b32 s99, s32, 2
  s_lshl_b32 s99, s99, 9
  s_add_u32 s99, s99, 22126592
  s_mul_i32 s49, s34, 66560
  s_add_u32 s49, s49, s48
  s_lshl_b32 s49, s49, 1
  s_add_u32 s49, s49, 17727488
  s_lshl_b32 s48, s48, 2
  s_add_u32 s48, s48, 22020096
  ds_read_b128 v[170:173], v249 offset:0
  ds_read_b128 v[174:177], v249 offset:1024
  ds_read_b128 v[178:181], v249 offset:2048
  ds_read_b128 v[182:185], v249 offset:3072
  ds_read_b128 v[186:189], v249 offset:4096
  v_mul_u32_u24 v6, 26, v0
  v_lshrrev_b32 v6, 8, v6
  v_mul_u32_u24 v7, 10, v6
  v_sub_u32 v7, v0, v7
  v_mul_u32_u24 v8, 272, v6
  v_lshrrev_b32 v9, 1, v7
  v_mul_u32_u24 v9, 2304, v9
  v_lshl_add_u32 v8, v7, 5, v8
  s_mul_i32 s36, s27, 47360
  s_lshl_b32 s37, s34, 6
  s_add_u32 s36, s36, s37
  s_add_u32 s36, s36, 20480
  v_add3_u32 v8, v8, v9, s36
  v_mul_u32_u24 v6, 1280, v6
  v_lshl_add_u32 v6, v7, 4, v6
  s_lshl_b32 s46, s32, 3
  s_add_u32 s46, s46, s26
  s_mul_i32 s46, s46, 10240
  s_mul_i32 s37, s33, 160
  s_add_u32 s46, s46, s37
  s_add_u32 s37, s46, 5120
  s_waitcnt lgkmcnt(0)
  s_barrier
  v_mfma_f32_16x16x32_bf16 v[130:133], v[210:213], v[170:173], 0
  ds_read_b128 v[190:193], v249 offset:20480
  v_mfma_f32_16x16x32_bf16 v[134:137], v[214:217], v[170:173], 0
  ds_read_b128 v[194:197], v249 offset:21504
  s_mov_b32 m0, s51
  s_add_u32 s45, s45, 2
  buffer_load_dwordx4 v244, s[52:55], s50 offen offset:0 sc1 lds
  v_mfma_f32_16x16x32_bf16 v[138:141], v[210:213], v[174:177], 0
  ds_read_b128 v[198:201], v249 offset:22528
  v_mfma_f32_16x16x32_bf16 v[142:145], v[214:217], v[174:177], 0
  ds_read_b128 v[202:205], v249 offset:23552
  buffer_load_dwordx4 v244, s[52:55], s50 offen offset:1024 sc1 lds
  v_mfma_f32_16x16x32_bf16 v[146:149], v[210:213], v[178:181], 0
  ds_read_b128 v[206:209], v249 offset:24576
  v_mfma_f32_16x16x32_bf16 v[150:153], v[214:217], v[178:181], 0
  buffer_load_dwordx4 v244, s[52:55], s50 offen offset:2048 sc1 lds
  v_mfma_f32_16x16x32_bf16 v[154:157], v[210:213], v[182:185], 0
  v_mfma_f32_16x16x32_bf16 v[158:161], v[214:217], v[182:185], 0
  v_mfma_f32_16x16x32_bf16 v[162:165], v[210:213], v[186:189], 0
  v_mfma_f32_16x16x32_bf16 v[166:169], v[214:217], v[186:189], 0
  s_waitcnt vmcnt(3) lgkmcnt(0)
  s_barrier
  s_cmp_eq_u32 s26, 0
  s_cbranch_scc0 k_f3
  s_mov_b64 exec, 2
  buffer_store_dword v246, v245, s[52:55], 0 offen sc1
  s_mov_b64 exec, -1
k_f3:
  v_mfma_f32_16x16x32_bf16 v[130:133], v[218:221], v[190:193], v[130:133]
  ds_read_b128 v[170:173], v249 offset:40960
  v_mfma_f32_16x16x32_bf16 v[134:137], v[222:225], v[190:193], v[134:137]
  ds_read_b128 v[174:177], v249 offset:41984
  buffer_load_dwordx4 v244, s[52:55], s50 offen offset:3072 sc1 lds
  v_mfma_f32_16x16x32_bf16 v[138:141], v[218:221], v[194:197], v[138:141]
  ds_read_b128 v[178:181], v249 offset:43008
  v_mfma_f32_16x16x32_bf16 v[142:145], v[222:225], v[194:197], v[142:145]
  ds_read_b128 v[182:185], v249 offset:44032
  s_add_u32 m0, m0, 4096
  s_add_u32 s50, s50, 4096
  buffer_load_dwordx4 v244, s[52:55], s50 offen offset:0 sc1 lds
  v_mfma_f32_16x16x32_bf16 v[146:149], v[218:221], v[198:201], v[146:149]
  ds_read_b128 v[186:189], v249 offset:45056
  v_mfma_f32_16x16x32_bf16 v[150:153], v[222:225], v[198:201], v[150:153]
  s_mul_i32 s50, s45, 163840
  s_add_u32 s50, s50, s40
  s_and_b32 s51, s45, 7
  s_mul_i32 s51, s51, 20480
  s_add_u32 s51, s51, s41
  v_mfma_f32_16x16x32_bf16 v[154:157], v[218:221], v[202:205], v[154:157]
  v_mfma_f32_16x16x32_bf16 v[158:161], v[222:225], v[202:205], v[158:161]
  s_mov_b32 m0, s51
  s_add_u32 s45, s45, 2
  buffer_load_dwordx4 v244, s[52:55], s50 offen offset:0 sc1 lds
  v_mfma_f32_16x16x32_bf16 v[162:165], v[218:221], v[206:209], v[162:165]
  v_mfma_f32_16x16x32_bf16 v[166:169], v[222:225], v[206:209], v[166:169]
  s_waitcnt lgkmcnt(0)
  s_barrier
  v_mfma_f32_16x16x32_bf16 v[130:133], v[226:229], v[170:173], v[130:133]
  ds_read_b128 v[190:193], v250 offset:0
  v_mfma_f32_16x16x32_bf16 v[134:137], v[230:233], v[170:173], v[134:137]
  ds_read_b128 v[194:197], v250 offset:1024
  buffer_load_dwordx4 v244, s[52:55], s50 offen offset:1024 sc1 lds
  v_mfma_f32_16x16x32_bf16 v[138:141], v[226:229], v[174:177], v[138:141]
  ds_read_b128 v[198:201], v250 offset:2048
  v_mfma_f32_16x16x32_bf16 v[142:145], v[230:233], v[174:177], v[142:145]
  ds_read_b128 v[202:205], v250 offset:3072
  buffer_load_dwordx4 v244, s[52:55], s50 offen offset:2048 sc1 lds
  v_mfma_f32_16x16x32_bf16 v[146:149], v[226:229], v[178:181], v[146:149]
  ds_read_b128 v[206:209], v250 offset:4096
  v_mfma_f32_16x16x32_bf16 v[150:153], v[230:233], v[178:181], v[150:153]
  buffer_load_dwordx4 v244, s[52:55], s50 offen offset:3072 sc1 lds
  v_mfma_f32_16x16x32_bf16 v[154:157], v[226:229], v[182:185], v[154:157]
  v_mfma_f32_16x16x32_bf16 v[158:161], v[230:233], v[182:185], v[158:161]
  v_mfma_f32_16x16x32_bf16 v[162:165], v[226:229], v[186:189], v[162:165]
  v_mfma_f32_16x16x32_bf16 v[166:169], v[230:233], v[186:189], v[166:169]
  s_waitcnt lgkmcnt(0)
  v_mfma_f32_16x16x32_bf16 v[130:133], v[234:237], v[190:193], v[130:133]
  ds_read_b128 v[170:173], v250 offset:20480
  v_mfma_f32_16x16x32_bf16 v[134:137], v[238:241], v[190:193], v[134:137]
  ds_read_b128 v[174:177], v250 offset:21504
  s_add_u32 m0, m0, 4096
  s_add_u32 s50, s50, 4096
  buffer_load_dwordx4 v244, s[52:55], s50 offen offset:0 sc1 lds
  v_mfma_f32_16x16x32_bf16 v[138:141], v[234:237], v[194:197], v[138:141]
  ds_read_b128 v[178:181], v250 offset:22528
  v_mfma_f32_16x16x32_bf16 v[142:145], v[238:241], v[194:197], v[142:145]
  ds_read_b128 v[182:185], v250 offset:23552
  s_mul_i32 s50, s45, 163840
  s_add_u32 s50, s50, s40
  s_and_b32 s51, s45, 7
  s_mul_i32 s51, s51, 20480
  s_add_u32 s51, s51, s41
  v_mfma_f32_16x16x32_bf16 v[146:149], v[234:237], v[198:201], v[146:149]
  ds_read_b128 v[186:189], v250 offset:24576
  v_mfma_f32_16x16x32_bf16 v[150:153], v[238:241], v[198:201], v[150:153]
  s_mov_b32 m0, s51
  s_add_u32 s45, s45, 2
  buffer_load_dwordx4 v244, s[52:55], s50 offen offset:0 sc1 lds
  v_mfma_f32_16x16x32_bf16 v[154:157], v[234:237], v[202:205], v[154:157]
  v_mfma_f32_16x16x32_bf16 v[158:161], v[238:241], v[202:205], v[158:161]
  buffer_load_dwordx4 v244, s[52:55], s50 offen offset:1024 sc1 lds
  v_mfma_f32_16x16x32_bf16 v[162:165], v[234:237], v[206:209], v[162:165]
  v_mfma_f32_16x16x32_bf16 v[166:169], v[238:241], v[206:209], v[166:169]
  s_waitcnt vmcnt(7) lgkmcnt(0)
  s_barrier
  v_mfma_f32_16x16x32_bf16 v[130:133], v[26:29], v[170:173], v[130:133]
  ds_read_b128 v[190:193], v250 offset:40960
  v_mfma_f32_16x16x32_bf16 v[134:137], v[30:33], v[170:173], v[134:137]
  ds_read_b128 v[194:197], v250 offset:41984
  buffer_load_dwordx4 v244, s[52:55], s50 offen offset:2048 sc1 lds
  v_mfma_f32_16x16x32_bf16 v[138:141], v[26:29], v[174:177], v[138:141]
  ds_read_b128 v[198:201], v250 offset:43008
  v_mfma_f32_16x16x32_bf16 v[142:145], v[30:33], v[174:177], v[142:145]
  ds_read_b128 v[202:205], v250 offset:44032
  buffer_load_dwordx4 v244, s[52:55], s50 offen offset:3072 sc1 lds
  v_mfma_f32_16x16x32_bf16 v[146:149], v[26:29], v[178:181], v[146:149]
  ds_read_b128 v[206:209], v250 offset:45056
  v_mfma_f32_16x16x32_bf16 v[150:153], v[30:33], v[178:181], v[150:153]
  s_add_u32 m0, m0, 4096
  s_add_u32 s50, s50, 4096
  buffer_load_dwordx4 v244, s[52:55], s50 offen offset:0 sc1 lds
  v_mfma_f32_16x16x32_bf16 v[154:157], v[26:29], v[182:185], v[154:157]
  v_mfma_f32_16x16x32_bf16 v[158:161], v[30:33], v[182:185], v[158:161]
  s_mul_i32 s50, s45, 163840
  s_add_u32 s50, s50, s40
  s_and_b32 s51, s45, 7
  s_mul_i32 s51, s51, 20480
  s_add_u32 s51, s51, s41
  v_mfma_f32_16x16x32_bf16 v[162:165], v[26:29], v[186:189], v[162:165]
  v_mfma_f32_16x16x32_bf16 v[166:169], v[30:33], v[186:189], v[166:169]
  s_waitcnt lgkmcnt(0)
  v_mfma_f32_16x16x32_bf16 v[130:133], v[34:37], v[190:193], v[130:133]
  ds_read_b128 v[170:173], v251 offset:0
  v_mfma_f32_16x16x32_bf16 v[134:137], v[38:41], v[190:193], v[134:137]
  ds_read_b128 v[174:177], v251 offset:1024
  s_mov_b32 m0, s51
  s_add_u32 s45, s45, 2
  buffer_load_dwordx4 v244, s[52:55], s50 offen offset:0 sc1 lds
  v_mfma_f32_16x16x32_bf16 v[138:141], v[34:37], v[194:197], v[138:141]
  ds_read_b128 v[178:181], v251 offset:2048
  v_mfma_f32_16x16x32_bf16 v[142:145], v[38:41], v[194:197], v[142:145]
  ds_read_b128 v[182:185], v251 offset:3072
  buffer_load_dwordx4 v244, s[52:55], s50 offen offset:1024 sc1 lds
  v_mfma_f32_16x16x32_bf16 v[146:149], v[34:37], v[198:201], v[146:149]
  ds_read_b128 v[186:189], v251 offset:4096
  v_mfma_f32_16x16x32_bf16 v[150:153], v[38:41], v[198:201], v[150:153]
  buffer_load_dwordx4 v244, s[52:55], s50 offen offset:2048 sc1 lds
  v_mfma_f32_16x16x32_bf16 v[154:157], v[34:37], v[202:205], v[154:157]
  v_mfma_f32_16x16x32_bf16 v[158:161], v[38:41], v[202:205], v[158:161]
  v_mfma_f32_16x16x32_bf16 v[162:165], v[34:37], v[206:209], v[162:165]
  v_mfma_f32_16x16x32_bf16 v[166:169], v[38:41], v[206:209], v[166:169]
  s_waitcnt vmcnt(8) lgkmcnt(0)
  s_barrier
  v_mfma_f32_16x16x32_bf16 v[130:133], v[42:45], v[170:173], v[130:133]
  ds_read_b128 v[190:193], v251 offset:20480
  v_mfma_f32_16x16x32_bf16 v[134:137], v[46:49], v[170:173], v[134:137]
  ds_read_b128 v[194:197], v251 offset:21504
  buffer_load_dwordx4 v244, s[52:55], s50 offen offset:3072 sc1 lds
  v_mfma_f32_16x16x32_bf16 v[138:141], v[42:45], v[174:177], v[138:141]
  ds_read_b128 v[198:201], v251 offset:22528
  v_mfma_f32_16x16x32_bf16 v[142:145], v[46:49], v[174:177], v[142:145]
  ds_read_b128 v[202:205], v251 offset:23552
  s_add_u32 m0, m0, 4096
  s_add_u32 s50, s50, 4096
  buffer_load_dwordx4 v244, s[52:55], s50 offen offset:0 sc1 lds
  v_mfma_f32_16x16x32_bf16 v[146:149], v[42:45], v[178:181], v[146:149]
  ds_read_b128 v[206:209], v251 offset:24576
  v_mfma_f32_16x16x32_bf16 v[150:153], v[46:49], v[178:181], v[150:153]
  s_mul_i32 s50, s45, 163840
  s_add_u32 s50, s50, s40
  s_and_b32 s51, s45, 7
  s_mul_i32 s51, s51, 20480
  s_add_u32 s51, s51, s41
  v_mfma_f32_16x16x32_bf16 v[154:157], v[42:45], v[182:185], v[154:157]
  v_mfma_f32_16x16x32_bf16 v[158:161], v[46:49], v[182:185], v[158:161]
  s_mov_b32 m0, s51
  s_add_u32 s45, s45, 2
  buffer_load_dwordx4 v244, s[52:55], s50 offen offset:0 sc1 lds
  v_mfma_f32_16x16x32_bf16 v[162:165], v[42:45], v[186:189], v[162:165]
  v_mfma_f32_16x16x32_bf16 v[166:169], v[46:49], v[186:189], v[166:169]
  s_waitcnt lgkmcnt(0)
  v_mfma_f32_16x16x32_bf16 v[130:133], v[50:53], v[190:193], v[130:133]
  ds_read_b128 v[170:173], v249 offset:0
  v_mfma_f32_16x16x32_bf16 v[134:137], v[54:57], v[190:193], v[134:137]
  ds_read_b128 v[174:177], v249 offset:1024
  buffer_load_dword v247, v3, s[52:55], s99 offen sc1
  v_mfma_f32_16x16x32_bf16 v[138:141], v[50:53], v[194:197], v[138:141]
  ds_read_b128 v[178:181], v249 offset:2048
  v_mfma_f32_16x16x32_bf16 v[142:145], v[54:57], v[194:197], v[142:145]
  ds_read_b128 v[182:185], v249 offset:3072
  buffer_load_dwordx4 v[122:125], v2, s[52:55], s48 offen offset:0 sc1
  v_mfma_f32_16x16x32_bf16 v[146:149], v[50:53], v[198:201], v[146:149]
  ds_read_b128 v[186:189], v249 offset:4096
  v_mfma_f32_16x16x32_bf16 v[150:153], v[54:57], v[198:201], v[150:153]
  buffer_load_dwordx4 v244, s[52:55], s50 offen offset:1024 sc1 lds
  v_mfma_f32_16x16x32_bf16 v[154:157], v[50:53], v[202:205], v[154:157]
  v_mfma_f32_16x16x32_bf16 v[158:161], v[54:57], v[202:205], v[158:161]
  buffer_load_dwordx4 v244, s[52:55], s50 offen offset:2048 sc1 lds
  v_mfma_f32_16x16x32_bf16 v[162:165], v[50:53], v[206:209], v[162:165]
  v_mfma_f32_16x16x32_bf16 v[166:169], v[54:57], v[206:209], v[166:169]
  s_waitcnt vmcnt(10) lgkmcnt(0)
  s_barrier
  v_mfma_f32_16x16x32_bf16 v[130:133], v[58:61], v[170:173], v[130:133]
  ds_read_b128 v[190:193], v249 offset:20480
  v_mfma_f32_16x16x32_bf16 v[134:137], v[62:65], v[170:173], v[134:137]
  ds_read_b128 v[194:197], v249 offset:21504
  buffer_load_dwordx4 v[126:129], v2, s[52:55], s48 offen offset:16 sc1
  v_mfma_f32_16x16x32_bf16 v[138:141], v[58:61], v[174:177], v[138:141]
  ds_read_b128 v[198:201], v249 offset:22528
  v_mfma_f32_16x16x32_bf16 v[142:145], v[62:65], v[174:177], v[142:145]
  ds_read_b128 v[202:205], v249 offset:23552
  buffer_load_dwordx4 v244, s[52:55], s50 offen offset:3072 sc1 lds
  v_mfma_f32_16x16x32_bf16 v[146:149], v[58:61], v[178:181], v[146:149]
  ds_read_b128 v[206:209], v249 offset:24576
  v_mfma_f32_16x16x32_bf16 v[150:153], v[62:65], v[178:181], v[150:153]
  s_add_u32 m0, m0, 4096
  s_add_u32 s50, s50, 4096
  buffer_load_dwordx4 v244, s[52:55], s50 offen offset:0 sc1 lds
  v_mfma_f32_16x16x32_bf16 v[154:157], v[58:61], v[182:185], v[154:157]
  v_mfma_f32_16x16x32_bf16 v[158:161], v[62:65], v[182:185], v[158:161]
  s_mul_i32 s50, s45, 163840
  s_add_u32 s50, s50, s40
  s_and_b32 s51, s45, 7
  s_mul_i32 s51, s51, 20480
  s_add_u32 s51, s51, s41
  v_mfma_f32_16x16x32_bf16 v[162:165], v[58:61], v[186:189], v[162:165]
  v_mfma_f32_16x16x32_bf16 v[166:169], v[62:65], v[186:189], v[166:169]
  s_waitcnt vmcnt(6) lgkmcnt(0)
  s_mov_b32 s98, 0
  s_branch spin4c
spin4:
  buffer_load_dword v247, v3, s[52:55], s99 offen sc1
  s_waitcnt vmcnt(0)
spin4c:
  v_cmp_ne_u32 vcc, 1, v247
  s_add_u32 s98, s98, 1
  s_cbranch_vccz spin4d
  s_cmp_lt_u32 s98, 0x40000
  s_cbranch_scc1 spin4
spin4d:
  v_mfma_f32_16x16x32_bf16 v[130:133], v[66:69], v[190:193], v[130:133]
  ds_read_b128 v[170:173], v249 offset:40960
  v_mfma_f32_16x16x32_bf16 v[134:137], v[70:73], v[190:193], v[134:137]
  ds_read_b128 v[174:177], v249 offset:41984
  s_add_u32 s36, s49, 6389760
  buffer_load_dwordx4 v[82:85], v4, s[52:55], s36 offen sc1
  v_mfma_f32_16x16x32_bf16 v[138:141], v[66:69], v[194:197], v[138:141]
  ds_read_b128 v[178:181], v249 offset:43008
  v_mfma_f32_16x16x32_bf16 v[142:145], v[70:73], v[194:197], v[142:145]
  ds_read_b128 v[182:185], v249 offset:44032
  s_add_u32 s36, s49, 6456320
  buffer_load_dwordx4 v[86:89], v4, s[52:55], s36 offen sc1
  v_mfma_f32_16x16x32_bf16 v[146:149], v[66:69], v[198:201], v[146:149]
  ds_read_b128 v[186:189], v249 offset:45056
  v_mfma_f32_16x16x32_bf16 v[150:153], v[70:73], v[198:201], v[150:153]
  s_add_u32 s36, s49, 6922240
  buffer_load_dwordx4 v[90:93], v4, s[52:55], s36 offen sc1
  v_mfma_f32_16x16x32_bf16 v[154:157], v[66:69], v[202:205], v[154:157]
  v_mfma_f32_16x16x32_bf16 v[158:161], v[70:73], v[202:205], v[158:161]
  s_add_u32 s36, s49, 6988800
  buffer_load_dwordx4 v[94:97], v4, s[52:55], s36 offen sc1
  v_mfma_f32_16x16x32_bf16 v[162:165], v[66:69], v[206:209], v[162:165]
  v_mfma_f32_16x16x32_bf16 v[166:169], v[70:73], v[206:209], v[166:169]
  s_waitcnt lgkmcnt(0)
  s_barrier
  v_mfma_f32_16x16x32_bf16 v[130:133], v[74:77], v[170:173], v[130:133]
  ds_read_b128 v[190:193], v250 offset:0
  v_mfma_f32_16x16x32_bf16 v[134:137], v[78:81], v[170:173], v[134:137]
  ds_read_b128 v[194:197], v250 offset:1024
  s_add_u32 s36, s49, 7454720
  buffer_load_dwordx4 v[98:101], v4, s[52:55], s36 offen sc1
  v_mfma_f32_16x16x32_bf16 v[138:141], v[74:77], v[174:177], v[138:141]
  ds_read_b128 v[198:201], v250 offset:2048
  v_mfma_f32_16x16x32_bf16 v[142:145], v[78:81], v[174:177], v[142:145]
  ds_read_b128 v[202:205], v250 offset:3072
  s_add_u32 s36, s49, 7521280
  buffer_load_dwordx4 v[102:105], v4, s[52:55], s36 offen sc1
  v_mfma_f32_16x16x32_bf16 v[146:149], v[74:77], v[178:181], v[146:149]
  ds_read_b128 v[206:209], v250 offset:4096
  v_mfma_f32_16x16x32_bf16 v[150:153], v[78:81], v[178:181], v[150:153]
  s_mov_b32 m0, s51
  s_add_u32 s45, s45, 2
  buffer_load_dwordx4 v244, s[52:55], s50 offen offset:0 sc1 lds
  v_mfma_f32_16x16x32_bf16 v[154:157], v[74:77], v[182:185], v[154:157]
  v_mfma_f32_16x16x32_bf16 v[158:161], v[78:81], v[182:185], v[158:161]
  buffer_load_dwordx4 v244, s[52:55], s50 offen offset:1024 sc1 lds
  v_mfma_f32_16x16x32_bf16 v[162:165], v[74:77], v[186:189], v[162:165]
  v_mfma_f32_16x16x32_bf16 v[166:169], v[78:81], v[186:189], v[166:169]
  s_waitcnt lgkmcnt(0)
  v_mfma_f32_16x16x32_bf16 v[130:133], v[14:17], v[190:193], v[130:133]
  ds_read_b128 v[170:173], v250 offset:20480
  v_mfma_f32_16x16x32_bf16 v[134:137], v[18:21], v[190:193], v[134:137]
  ds_read_b128 v[174:177], v250 offset:21504
  buffer_load_dwordx4 v244, s[52:55], s50 offen offset:2048 sc1 lds
  v_mfma_f32_16x16x32_bf16 v[138:141], v[14:17], v[194:197], v[138:141]
  ds_read_b128 v[178:181], v250 offset:22528
  v_mfma_f32_16x16x32_bf16 v[142:145], v[18:21], v[194:197], v[142:145]
  ds_read_b128 v[182:185], v250 offset:23552
  buffer_load_dwordx4 v244, s[52:55], s50 offen offset:3072 sc1 lds
  v_mfma_f32_16x16x32_bf16 v[146:149], v[14:17], v[198:201], v[146:149]
  ds_read_b128 v[186:189], v250 offset:24576
  v_mfma_f32_16x16x32_bf16 v[150:153], v[18:21], v[198:201], v[150:153]
  s_add_u32 m0, m0, 4096
  s_add_u32 s50, s50, 4096
  buffer_load_dwordx4 v244, s[52:55], s50 offen offset:0 sc1 lds
  v_mfma_f32_16x16x32_bf16 v[154:157], v[14:17], v[202:205], v[154:157]
  v_mfma_f32_16x16x32_bf16 v[158:161], v[18:21], v[202:205], v[158:161]
  s_mul_i32 s50, s45, 163840
  s_add_u32 s50, s50, s40
  s_and_b32 s51, s45, 7
  s_mul_i32 s51, s51, 20480
  s_add_u32 s51, s51, s41
  v_mfma_f32_16x16x32_bf16 v[162:165], v[14:17], v[206:209], v[162:165]
  v_mfma_f32_16x16x32_bf16 v[166:169], v[18:21], v[206:209], v[166:169]
  s_waitcnt vmcnt(9) lgkmcnt(0)
  s_barrier
  v_sub_f32 v122, 1.0, v122
  v_sub_f32 v123, 1.0, v123
  v_sub_f32 v124, 1.0, v124
  v_sub_f32 v125, 1.0, v125
  v_sub_f32 v126, 1.0, v126
  v_sub_f32 v127, 1.0, v127
  v_sub_f32 v128, 1.0, v128
  v_sub_f32 v129, 1.0, v129
  v_mul_f32 v130, v122, v130
  v_mul_f32 v131, v124, v131
  v_mul_f32 v132, v126, v132
  v_mul_f32 v133, v128, v133
  v_mul_f32 v134, v123, v134
  v_mul_f32 v135, v125, v135
  v_mul_f32 v136, v127, v136
  v_mul_f32 v137, v129, v137
  v_mul_f32 v138, v122, v138
  v_mul_f32 v139, v124, v139
  v_mul_f32 v140, v126, v140
  v_mul_f32 v141, v128, v141
  v_mul_f32 v142, v123, v142
  v_mul_f32 v143, v125, v143
  v_mul_f32 v144, v127, v144
  v_mul_f32 v145, v129, v145
  v_mul_f32 v146, v122, v146
  v_mul_f32 v147, v124, v147
  v_mul_f32 v148, v126, v148
  v_mul_f32 v149, v128, v149
  v_mul_f32 v150, v123, v150
  v_mul_f32 v151, v125, v151
  v_mul_f32 v152, v127, v152
  v_mul_f32 v153, v129, v153
  v_mul_f32 v154, v122, v154
  v_mul_f32 v155, v124, v155
  v_mul_f32 v156, v126, v156
  v_mul_f32 v157, v128, v157
  v_mul_f32 v158, v123, v158
  v_mul_f32 v159, v125, v159
  v_mul_f32 v160, v127, v160
  v_mul_f32 v161, v129, v161
  v_mul_f32 v162, v122, v162
  v_mul_f32 v163, v124, v163
  v_mul_f32 v164, v126, v164
  v_mul_f32 v165, v128, v165
  v_mul_f32 v166, v123, v166
  v_mul_f32 v167, v125, v167
  v_mul_f32 v168, v127, v168
  v_mul_f32 v169, v129, v169
  v_swap_b32 v84, v86
  v_swap_b32 v85, v87
  s_nop 1
  v_mfma_f32_16x16x32_bf16 v[130:133], v[82:85], v[170:173], v[130:133]
  ds_read_b128 v[190:193], v250 offset:40960
  v_mfma_f32_16x16x32_bf16 v[134:137], v[86:89], v[170:173], v[134:137]
  ds_read_b128 v[194:197], v250 offset:41984
  s_add_u32 s36, s49, 7987200
  buffer_load_dwordx4 v[106:109], v4, s[52:55], s36 offen sc1
  v_mfma_f32_16x16x32_bf16 v[138:141], v[82:85], v[174:177], v[138:141]
  ds_read_b128 v[198:201], v250 offset:43008
  v_mfma_f32_16x16x32_bf16 v[142:145], v[86:89], v[174:177], v[142:145]
  ds_read_b128 v[202:205], v250 offset:44032
  s_add_u32 s36, s49, 8053760
  buffer_load_dwordx4 v[110:113], v4, s[52:55], s36 offen sc1
  v_mfma_f32_16x16x32_bf16 v[146:149], v[82:85], v[178:181], v[146:149]
  ds_read_b128 v[206:209], v250 offset:45056
  v_mfma_f32_16x16x32_bf16 v[150:153], v[86:89], v[178:181], v[150:153]
  s_add_u32 s36, s49, 8519680
  buffer_load_dwordx4 v[114:117], v4, s[52:55], s36 offen sc1
  v_mfma_f32_16x16x32_bf16 v[154:157], v[82:85], v[182:185], v[154:157]
  v_mfma_f32_16x16x32_bf16 v[158:161], v[86:89], v[182:185], v[158:161]
  s_add_u32 s36, s49, 8586240
  buffer_load_dwordx4 v[118:121], v4, s[52:55], s36 offen sc1
  v_mfma_f32_16x16x32_bf16 v[162:165], v[82:85], v[186:189], v[162:165]
  v_mfma_f32_16x16x32_bf16 v[166:169], v[86:89], v[186:189], v[166:169]
  s_waitcnt vmcnt(11) lgkmcnt(0)
  v_swap_b32 v92, v94
  v_swap_b32 v93, v95
  s_nop 1
  v_mfma_f32_16x16x32_bf16 v[130:133], v[90:93], v[190:193], v[130:133]
  ds_read_b128 v[170:173], v251 offset:0
  v_mfma_f32_16x16x32_bf16 v[134:137], v[94:97], v[190:193], v[134:137]
  ds_read_b128 v[174:177], v251 offset:1024
  v_mfma_f32_16x16x32_bf16 v[138:141], v[90:93], v[194:197], v[138:141]
  ds_read_b128 v[178:181], v251 offset:2048
  v_mfma_f32_16x16x32_bf16 v[142:145], v[94:97], v[194:197], v[142:145]
  ds_read_b128 v[182:185], v251 offset:3072
  v_mfma_f32_16x16x32_bf16 v[146:149], v[90:93], v[198:201], v[146:149]
  ds_read_b128 v[186:189], v251 offset:4096
  v_mfma_f32_16x16x32_bf16 v[150:153], v[94:97], v[198:201], v[150:153]
  v_mfma_f32_16x16x32_bf16 v[154:157], v[90:93], v[202:205], v[154:157]
  v_mfma_f32_16x16x32_bf16 v[158:161], v[94:97], v[202:205], v[158:161]
  v_mfma_f32_16x16x32_bf16 v[162:165], v[90:93], v[206:209], v[162:165]
  v_mfma_f32_16x16x32_bf16 v[166:169], v[94:97], v[206:209], v[166:169]
  s_waitcnt vmcnt(4) lgkmcnt(0)
  s_barrier
  v_swap_b32 v100, v102
  v_swap_b32 v101, v103
  s_nop 1
  v_mfma_f32_16x16x32_bf16 v[130:133], v[98:101], v[170:173], v[130:133]
  ds_read_b128 v[190:193], v251 offset:20480
  v_mfma_f32_16x16x32_bf16 v[134:137], v[102:105], v[170:173], v[134:137]
  ds_read_b128 v[194:197], v251 offset:21504
  v_mfma_f32_16x16x32_bf16 v[138:141], v[98:101], v[174:177], v[138:141]
  ds_read_b128 v[198:201], v251 offset:22528
  v_mfma_f32_16x16x32_bf16 v[142:145], v[102:105], v[174:177], v[142:145]
  ds_read_b128 v[202:205], v251 offset:23552
  v_mfma_f32_16x16x32_bf16 v[146:149], v[98:101], v[178:181], v[146:149]
  ds_read_b128 v[206:209], v251 offset:24576
  v_mfma_f32_16x16x32_bf16 v[150:153], v[102:105], v[178:181], v[150:153]
  v_mfma_f32_16x16x32_bf16 v[154:157], v[98:101], v[182:185], v[154:157]
  v_mfma_f32_16x16x32_bf16 v[158:161], v[102:105], v[182:185], v[158:161]
  v_mfma_f32_16x16x32_bf16 v[162:165], v[98:101], v[186:189], v[162:165]
  v_mfma_f32_16x16x32_bf16 v[166:169], v[102:105], v[186:189], v[166:169]
  s_waitcnt vmcnt(2) lgkmcnt(0)
  v_swap_b32 v108, v110
  v_swap_b32 v109, v111
  s_nop 1
  v_mfma_f32_16x16x32_bf16 v[130:133], v[106:109], v[190:193], v[130:133]
  ds_read_b128 v[170:173], v249 offset:0
  v_mfma_f32_16x16x32_bf16 v[134:137], v[110:113], v[190:193], v[134:137]
  ds_read_b128 v[174:177], v249 offset:1024
  v_mfma_f32_16x16x32_bf16 v[138:141], v[106:109], v[194:197], v[138:141]
  ds_read_b128 v[178:181], v249 offset:2048
  v_mfma_f32_16x16x32_bf16 v[142:145], v[110:113], v[194:197], v[142:145]
  ds_read_b128 v[182:185], v249 offset:3072
  v_mfma_f32_16x16x32_bf16 v[146:149], v[106:109], v[198:201], v[146:149]
  ds_read_b128 v[186:189], v249 offset:4096
  v_mfma_f32_16x16x32_bf16 v[150:153], v[110:113], v[198:201], v[150:153]
  v_mfma_f32_16x16x32_bf16 v[154:157], v[106:109], v[202:205], v[154:157]
  v_mfma_f32_16x16x32_bf16 v[158:161], v[110:113], v[202:205], v[158:161]
  v_mfma_f32_16x16x32_bf16 v[162:165], v[106:109], v[206:209], v[162:165]
  v_mfma_f32_16x16x32_bf16 v[166:169], v[110:113], v[206:209], v[166:169]
  s_waitcnt vmcnt(0) lgkmcnt(0)
  v_swap_b32 v116, v118
  v_swap_b32 v117, v119
  s_nop 1
  v_mfma_f32_16x16x32_bf16 v[130:133], v[114:117], v[170:173], v[130:133]
  s_mul_i32 s36, s34, 11840
  s_add_u32 m0, s36, 20480
  s_cmp_eq_u32 s27, 0
  v_mfma_f32_16x16x32_bf16 v[134:137], v[118:121], v[170:173], v[134:137]
  v_mfma_f32_16x16x32_bf16 v[138:141], v[114:117], v[174:177], v[138:141]
  v_mfma_f32_16x16x32_bf16 v[142:145], v[118:121], v[174:177], v[142:145]
  v_mfma_f32_16x16x32_bf16 v[146:149], v[114:117], v[178:181], v[146:149]
  v_mfma_f32_16x16x32_bf16 v[150:153], v[118:121], v[178:181], v[150:153]
  v_mfma_f32_16x16x32_bf16 v[154:157], v[114:117], v[182:185], v[154:157]
  v_mfma_f32_16x16x32_bf16 v[158:161], v[118:121], v[182:185], v[158:161]
  v_mfma_f32_16x16x32_bf16 v[162:165], v[114:117], v[186:189], v[162:165]
  v_mfma_f32_16x16x32_bf16 v[166:169], v[118:121], v[186:189], v[166:169]
  s_cbranch_scc1 k_rw0
  ds_write_addtid_b32 v130 offset:47360
  ds_write_addtid_b32 v131 offset:47904
  ds_write_addtid_b32 v132 offset:48448
  ds_write_addtid_b32 v133 offset:48992
  ds_write_addtid_b32 v134 offset:47632
  ds_write_addtid_b32 v135 offset:48176
  ds_write_addtid_b32 v136 offset:48720
  ds_write_addtid_b32 v137 offset:49264
  ds_write_addtid_b32 v138 offset:49728
  ds_write_addtid_b32 v139 offset:50272
  ds_write_addtid_b32 v140 offset:50816
  ds_write_addtid_b32 v141 offset:51360
  ds_write_addtid_b32 v142 offset:50000
  ds_write_addtid_b32 v143 offset:50544
  ds_write_addtid_b32 v144 offset:51088
  ds_write_addtid_b32 v145 offset:51632
  ds_write_addtid_b32 v146 offset:52096
  ds_write_addtid_b32 v147 offset:52640
  ds_write_addtid_b32 v148 offset:53184
  ds_write_addtid_b32 v149 offset:53728
  ds_write_addtid_b32 v150 offset:52368
  ds_write_addtid_b32 v151 offset:52912
  ds_write_addtid_b32 v152 offset:53456
  ds_write_addtid_b32 v153 offset:54000
  ds_write_addtid_b32 v154 offset:54464
  ds_write_addtid_b32 v155 offset:55008
  ds_write_addtid_b32 v156 offset:55552
  ds_write_addtid_b32 v157 offset:56096
  ds_write_addtid_b32 v158 offset:54736
  ds_write_addtid_b32 v159 offset:55280
  ds_write_addtid_b32 v160 offset:55824
  ds_write_addtid_b32 v161 offset:56368
  ds_write_addtid_b32 v162 offset:56832
  ds_write_addtid_b32 v163 offset:57376
  ds_write_addtid_b32 v164 offset:57920
  ds_write_addtid_b32 v165 offset:58464
  ds_write_addtid_b32 v166 offset:57104
  ds_write_addtid_b32 v167 offset:57648
  ds_write_addtid_b32 v168 offset:58192
  ds_write_addtid_b32 v169 offset:58736
  s_branch k_rw1
k_rw0:
  ds_write_addtid_b32 v130 offset:0
  ds_write_addtid_b32 v131 offset:544
  ds_write_addtid_b32 v132 offset:1088
  ds_write_addtid_b32 v133 offset:1632
  ds_write_addtid_b32 v134 offset:272
  ds_write_addtid_b32 v135 offset:816
  ds_write_addtid_b32 v136 offset:1360
  ds_write_addtid_b32 v137 offset:1904
  ds_write_addtid_b32 v138 offset:2368
  ds_write_addtid_b32 v139 offset:2912
  ds_write_addtid_b32 v140 offset:3456
  ds_write_addtid_b32 v141 offset:4000
  ds_write_addtid_b32 v142 offset:2640
  ds_write_addtid_b32 v143 offset:3184
  ds_write_addtid_b32 v144 offset:3728
  ds_write_addtid_b32 v145 offset:4272
  ds_write_addtid_b32 v146 offset:4736
  ds_write_addtid_b32 v147 offset:5280
  ds_write_addtid_b32 v148 offset:5824
  ds_write_addtid_b32 v149 offset:6368
  ds_write_addtid_b32 v150 offset:5008
  ds_write_addtid_b32 v151 offset:5552
  ds_write_addtid_b32 v152 offset:6096
  ds_write_addtid_b32 v153 offset:6640
  ds_write_addtid_b32 v154 offset:7104
  ds_write_addtid_b32 v155 offset:7648
  ds_write_addtid_b32 v156 offset:8192
  ds_write_addtid_b32 v157 offset:8736
  ds_write_addtid_b32 v158 offset:7376
  ds_write_addtid_b32 v159 offset:7920
  ds_write_addtid_b32 v160 offset:8464
  ds_write_addtid_b32 v161 offset:9008
  ds_write_addtid_b32 v162 offset:9472
  ds_write_addtid_b32 v163 offset:10016
  ds_write_addtid_b32 v164 offset:10560
  ds_write_addtid_b32 v165 offset:11104
  ds_write_addtid_b32 v166 offset:9744
  ds_write_addtid_b32 v167 offset:10288
  ds_write_addtid_b32 v168 offset:10832
  ds_write_addtid_b32 v169 offset:11376
k_rw1:
  s_waitcnt lgkmcnt(0)
  s_barrier
  s_mov_b32 exec_hi, 0xff
  ds_read_b128 v[26:29], v8 offset:0
  ds_read_b128 v[30:33], v8 offset:16
  ds_read_b128 v[34:37], v8 offset:11840
  ds_read_b128 v[38:41], v8 offset:11856
  ds_read_b128 v[42:45], v8 offset:23680
  ds_read_b128 v[46:49], v8 offset:23696
  ds_read_b128 v[50:53], v8 offset:35520
  ds_read_b128 v[54:57], v8 offset:35536
  ds_read_b128 v[58:61], v8 offset:1088
  ds_read_b128 v[62:65], v8 offset:1104
  ds_read_b128 v[66:69], v8 offset:12928
  ds_read_b128 v[70:73], v8 offset:12944
  ds_read_b128 v[74:77], v8 offset:24768
  ds_read_b128 v[78:81], v8 offset:24784
  ds_read_b128 v[82:85], v8 offset:36608
  s_waitcnt lgkmcnt(14)
  ds_read_b128 v[86:89], v8 offset:36624
  s_waitcnt lgkmcnt(8)
  v_add_f32 v26, v26, v34
  v_add_f32 v42, v42, v50
  v_add_f32 v27, v27, v35
  v_add_f32 v43, v43, v51
  v_add_f32 v28, v28, v36
  v_add_f32 v44, v44, v52
  v_add_f32 v29, v29, v37
  v_add_f32 v45, v45, v53
  v_add_f32 v30, v30, v38
  v_add_f32 v46, v46, v54
  v_add_f32 v31, v31, v39
  v_add_f32 v47, v47, v55
  v_add_f32 v32, v32, v40
  v_add_f32 v48, v48, v56
  v_add_f32 v33, v33, v41
  v_add_f32 v49, v49, v57
  v_add_f32 v26, v26, v42
  v_add_f32 v27, v27, v43
  v_add_f32 v28, v28, v44
  v_add_f32 v29, v29, v45
  v_add_f32 v30, v30, v46
  v_add_f32 v31, v31, v47
  v_add_f32 v32, v32, v48
  v_add_f32 v33, v33, v49
  v_cvt_pk_bf16_f32 v34, v26, v27
  v_cvt_pk_bf16_f32 v35, v28, v29
  v_cvt_pk_bf16_f32 v36, v30, v31
  v_cvt_pk_bf16_f32 v37, v32, v33
  buffer_store_dwordx4 v[34:37], v6, s[28:31], s46 offen
  s_waitcnt lgkmcnt(0)
  v_add_f32 v58, v58, v66
  v_add_f32 v74, v74, v82
  v_add_f32 v59, v59, v67
  v_add_f32 v75, v75, v83
  v_add_f32 v60, v60, v68
  v_add_f32 v76, v76, v84
  v_add_f32 v61, v61, v69
  v_add_f32 v77, v77, v85
  v_add_f32 v62, v62, v70
  v_add_f32 v78, v78, v86
  v_add_f32 v63, v63, v71
  v_add_f32 v79, v79, v87
  v_add_f32 v64, v64, v72
  v_add_f32 v80, v80, v88
  v_add_f32 v65, v65, v73
  v_add_f32 v81, v81, v89
  v_add_f32 v58, v58, v74
  v_add_f32 v59, v59, v75
  v_add_f32 v60, v60, v76
  v_add_f32 v61, v61, v77
  v_add_f32 v62, v62, v78
  v_add_f32 v63, v63, v79
  v_add_f32 v64, v64, v80
  v_add_f32 v65, v65, v81
  v_cvt_pk_bf16_f32 v66, v58, v59
  v_cvt_pk_bf16_f32 v67, v60, v61
  v_cvt_pk_bf16_f32 v68, v62, v63
  v_cvt_pk_bf16_f32 v69, v64, v65
  buffer_store_dwordx4 v[66:69], v6, s[28:31], s37 offen
  s_mov_b64 exec, -1
k_end:
  s_endpgm
.section .rodata,"a"
.p2align 6
.amdhsa_kernel gated_mix__sliding_block__swiglu_ffn__prompt_kernel
  .amdhsa_next_free_vgpr 256
  .amdhsa_next_free_sgpr 102
  .amdhsa_accum_offset 256
  .amdhsa_group_segment_fixed_size 0
  .amdhsa_kernarg_size 88
  .amdhsa_user_sgpr_count 2
  .amdhsa_user_sgpr_kernarg_segment_ptr 1
  .amdhsa_system_sgpr_workgroup_id_x 1
.end_amdhsa_kernel
```
